```python
import torch

def _softmax(x, axis=-1):
    return torch.softmax(x, dim=axis)
def _gelu(x):
    return torch.nn.functional.gelu(x, approximate="tanh")
def _silu(x):
    return torch.nn.functional.silu(x)
def _sigmoid(x):
    return torch.sigmoid(x)
def _layernorm(x, axis=-1, eps=1e-5):
    m = x.mean(dim=axis, keepdim=True)
    v = x.var(dim=axis, keepdim=True, unbiased=False)
    return (x - m) / torch.sqrt(v + eps)
def _scatter_add(tgt, idx, src, axis=0):
    return tgt.clone().index_add_(axis, idx, src)
def _segment_sum(src, seg, n):
    out = torch.zeros((n,) + src.shape[1:], dtype=src.dtype)
    return out.index_add_(0, seg, src)
def _pad(x, pw):
    flat = tuple(v for pair in reversed(pw) for v in pair)
    return torch.nn.functional.pad(x, flat)

kernel_name = 'sequential_preLN__gqa_block_cached__dense_activation_gelu__decode'

def setup_inputs():

    _w = (lambda a: (lambda t: t.to(torch.bfloat16) if t.is_floating_point() else t)(torch.as_tensor(a)))
    def _A_setup():
        B, Sq, D = 2, 1, 576
        Hq, Hkv, Sk, Dh = 32, 16, 32768, 128
        assert Hq % Hkv == 0, (Hq, Hkv)
        return {
            "x": _w((lambda *s: torch.randn(*s, dtype=torch.bfloat16) * 0.1)(B, Sq, D)),
            "k_cache": _w((lambda *s: torch.randn(*s, dtype=torch.bfloat16) * 1.6)(B, Hkv, Sk, Dh)),
            "v_cache": _w((lambda *s: torch.randn(*s, dtype=torch.bfloat16) * 1.6)(B, Hkv, Sk, Dh)),
            "wq": _w((lambda *s: torch.randn(*s, dtype=torch.bfloat16) * 1.6)(D, Hq * Dh) * (D ** -0.5)),
            "wo": _w((lambda *s: torch.randn(*s, dtype=torch.bfloat16) * 1.6)(Hq * Dh, D) * ((Hq * Dh) ** -0.5)),
        }
    _A_in = _A_setup()

    def _B_setup():
        B, S, D, F = 2, 1, 576, 4608
        return {
            "x": _w((lambda *s: torch.randn(*s, dtype=torch.bfloat16) * 0.1)(B, S, D)),
            "w1": _w((lambda *s: torch.randn(*s, dtype=torch.bfloat16) * 3.2)(D, F) * (D ** -0.5)),
            "b1": _w((lambda *s: torch.randn(*s, dtype=torch.bfloat16) * 3.2)(F) * 0.01),
            "w2": _w((lambda *s: torch.randn(*s, dtype=torch.bfloat16) * 3.2)(F, D) * (F ** -0.5)),
            "b2": _w((lambda *s: torch.randn(*s, dtype=torch.bfloat16) * 3.2)(D) * 0.01),
        }
    _B_in = _B_setup()

    return {
        "A_x": _A_in["x"],
        "A_k_cache": _A_in["k_cache"],
        "A_v_cache": _A_in["v_cache"],
        "A_wq": _A_in["wq"],
        "A_wo": _A_in["wo"],
        "B_x": _B_in["x"],
        "B_w1": _B_in["w1"],
        "B_b1": _B_in["b1"],
        "B_w2": _B_in["w2"],
        "B_b2": _B_in["b2"],
    }

def reference(A_x, A_k_cache, A_v_cache, A_wq, A_wo, B_x, B_w1, B_b1, B_w2, B_b2):
    def _A_ref(x, k_cache, v_cache, wq, wo):
        B, Sq, D = x.shape
        Hq, Dh = 32, 128
        Hkv = k_cache.shape[1]
        rep = Hq // Hkv
        q = (lambda x, *d: x.permute(*d))((x @ wq).reshape(B, Sq, Hq, Dh), 0, 2, 1, 3)
        k = (lambda x, n, axis: torch.repeat_interleave(x, n, dim=axis))(k_cache, rep, axis=1)
        v = (lambda x, n, axis: torch.repeat_interleave(x, n, dim=axis))(v_cache, rep, axis=1)
        scores = torch.einsum("bhqd,bhkd->bhqk", q, k) * (Dh ** -0.5)
        p = _softmax(scores, axis=-1)
        o = torch.einsum("bhqk,bhkd->bhqd", p, v)
        return (lambda x, *d: x.permute(*d))(o, 0, 2, 1, 3).reshape(B, Sq, Hq * Dh) @ wo

    def _B_ref(x, w1, b1, w2, b2):
        h = torch.einsum("bsd,df->bsf", x, w1) + b1
        h = _gelu(h)
        return torch.einsum("bsf,fd->bsd", h, w2) + b2

    x = A_x
    h = x + _A_ref(_layernorm(x, axis=-1), A_k_cache, A_v_cache, A_wq, A_wo)
    h2 = h + _B_ref(_layernorm(h, axis=-1), B_w1, B_b1, B_w2, B_b2)
    return h2
```

```asm
; @launch grid=(256,1,1) block=(512,1,1) lds=90000
.amdgcn_target "amdgcn-amd-amdhsa--gfx950"
.text
.globl sequential_preLN__gqa_block_cached__dense_activation_gelu__decode_kernel
.p2align 8
.type sequential_preLN__gqa_block_cached__dense_activation_gelu__decode_kernel,@function
sequential_preLN__gqa_block_cached__dense_activation_gelu__decode_kernel:
s_cmp_ge_u32 s2, 256
s_cbranch_scc1 L_exit
s_mov_b32 s93, 0
s_load_dwordx16 s[36:51], s[0:1], 0
s_load_dwordx8 s[52:59], s[0:1], 64
s_load_dwordx2 s[60:61], s[0:1], 96
v_lshrrev_b32 v48, 6, v0
v_and_b32 v1, 63, v0
v_readfirstlane_b32 s3, v48
v_and_b32 v2, 15, v1
v_lshrrev_b32 v3, 4, v1
v_lshlrev_b32 v4, 8, v2
v_lshl_add_u32 v4, v3, 4, v4
v_lshlrev_b32 v5, 4, v2
v_lshl_add_u32 v5, v3, 10, v5
v_mov_b32 v57, 0
v_lshlrev_b32 v61, 4, v1
s_lshr_b32 s62, s2, 3
s_and_b32 s62, s62, 15
s_lshr_b32 s63, s2, 7
s_and_b32 s64, s2, 7
s_lshl_b32 s65, s63, 3
s_add_u32 s65, s65, s64
s_lshl_b32 s66, s2, 20
s_andn2_b32 s89, s2, 15
s_lshl_b32 s67, s64, 1
s_add_u32 s89, s89, s67
s_bfe_u32 s67, s2, 0x10003
s_add_u32 s89, s89, s67

s_mov_b32 s76, 0x3e0293ee
s_mov_b32 s77, 0xbe0293ee
s_waitcnt lgkmcnt(0)
s_load_dword s80, s[60:61], 262144
s_sub_u32 s89, s89, 112
s_sub_u32 s97, s2, 112
s_mov_b32 s4, s38
s_and_b32 s5, s39, 0xffff
s_mov_b32 s6, 268435456
s_mov_b32 s7, 0x20000
s_mov_b32 s8, s40
s_and_b32 s9, s41, 0xffff
s_mov_b32 s10, 268435456
s_mov_b32 s11, 0x20000
s_mov_b32 s12, s60
s_and_b32 s13, s61, 0xffff
s_mov_b32 s14, 1073741824
s_mov_b32 s15, 0x20000
s_cmp_eq_u32 s3, 0
s_cbranch_scc1 L_qphase
s_barrier
s_lshl_b32 s67, s3, 12
s_add_u32 s67, s67, s66
buffer_load_dwordx4 v[64:67], v4, s[4:7], s67 offen offset:0 nt
buffer_load_dwordx4 v[68:71], v4, s[4:7], s67 offen offset:64 nt
buffer_load_dwordx4 v[72:75], v4, s[4:7], s67 offen offset:128 nt
buffer_load_dwordx4 v[76:79], v4, s[4:7], s67 offen offset:192 nt
buffer_load_dwordx4 v[80:83], v5, s[8:11], s67 offen offset:0 nt
buffer_load_dwordx4 v[84:87], v5, s[8:11], s67 offen offset:256 nt
buffer_load_dwordx4 v[88:91], v5, s[8:11], s67 offen offset:512 nt
buffer_load_dwordx4 v[92:95], v5, s[8:11], s67 offen offset:768 nt
s_add_u32 s67, s67, 32768
buffer_load_dwordx4 v[96:99], v4, s[4:7], s67 offen offset:0 nt
buffer_load_dwordx4 v[100:103], v4, s[4:7], s67 offen offset:64 nt
buffer_load_dwordx4 v[104:107], v4, s[4:7], s67 offen offset:128 nt
buffer_load_dwordx4 v[108:111], v4, s[4:7], s67 offen offset:192 nt
buffer_load_dwordx4 v[112:115], v5, s[8:11], s67 offen offset:0 nt
buffer_load_dwordx4 v[116:119], v5, s[8:11], s67 offen offset:256 nt
buffer_load_dwordx4 v[120:123], v5, s[8:11], s67 offen offset:512 nt
buffer_load_dwordx4 v[124:127], v5, s[8:11], s67 offen offset:768 nt
s_add_u32 s67, s67, 32768
buffer_load_dwordx4 v[128:131], v4, s[4:7], s67 offen offset:0 nt
buffer_load_dwordx4 v[132:135], v4, s[4:7], s67 offen offset:64 nt
buffer_load_dwordx4 v[136:139], v4, s[4:7], s67 offen offset:128 nt
buffer_load_dwordx4 v[140:143], v4, s[4:7], s67 offen offset:192 nt
buffer_load_dwordx4 v[144:147], v5, s[8:11], s67 offen offset:0 nt
buffer_load_dwordx4 v[148:151], v5, s[8:11], s67 offen offset:256 nt
buffer_load_dwordx4 v[152:155], v5, s[8:11], s67 offen offset:512 nt
buffer_load_dwordx4 v[156:159], v5, s[8:11], s67 offen offset:768 nt
s_add_u32 s67, s67, 32768
buffer_load_dwordx4 v[160:163], v4, s[4:7], s67 offen offset:0 nt
buffer_load_dwordx4 v[164:167], v4, s[4:7], s67 offen offset:64 nt
buffer_load_dwordx4 v[168:171], v4, s[4:7], s67 offen offset:128 nt
buffer_load_dwordx4 v[172:175], v4, s[4:7], s67 offen offset:192 nt
buffer_load_dwordx4 v[176:179], v5, s[8:11], s67 offen offset:0 nt
buffer_load_dwordx4 v[180:183], v5, s[8:11], s67 offen offset:256 nt
buffer_load_dwordx4 v[184:187], v5, s[8:11], s67 offen offset:512 nt
buffer_load_dwordx4 v[188:191], v5, s[8:11], s67 offen offset:768 nt
L_masks:
s_waitcnt lgkmcnt(0)
s_add_u32 s80, s80, 0x9e3779b9
v_and_b32 v48, 1, v2
v_lshlrev_b32 v48, 4, v48
v_mov_b32 v49, 0xffff
v_lshlrev_b32 v49, v48, v49
v_bfe_u32 v48, v2, 1, 2
v_cmp_eq_u32 vcc, 0, v48
s_nop 1
v_cndmask_b32 v6, 0, v49, vcc
v_cmp_eq_u32 vcc, 1, v48
s_nop 1
v_cndmask_b32 v7, 0, v49, vcc
v_cmp_eq_u32 vcc, 2, v48
s_nop 1
v_cndmask_b32 v8, 0, v49, vcc
v_cmp_eq_u32 vcc, 3, v48
s_nop 1
v_cndmask_b32 v9, 0, v49, vcc
s_cmp_eq_u32 s3, 0
s_cbranch_scc1 L_qphase2
s_barrier
s_branch L_main
L_qphase:
s_mov_b32 s20, s36
s_and_b32 s21, s37, 0xffff
s_mov_b32 s22, 2304
s_mov_b32 s23, 0x20000
s_mov_b32 s24, s42
s_and_b32 s25, s43, 0xffff
s_mov_b32 s26, 4718592
s_mov_b32 s27, 0x20000
v_lshrrev_b32 v48, 5, v1
v_and_b32 v49, 31, v1
v_mul_u32_u24 v50, 1152, v48
v_lshl_add_u32 v51, v49, 4, v50
v_lshl_add_u32 v50, v49, 2, v50
buffer_load_dwordx4 v[200:203], v51, s[20:23], 0 offen
buffer_load_dwordx4 v[204:207], v51, s[20:23], 0 offen offset:512
buffer_load_dword v208, v50, s[20:23], 0 offen offset:1024
s_lshl_b32 s67, s62, 1
s_add_u32 s67, s67, s63
s_lshl_b32 s67, s67, 8
s_mul_i32 s68, s64, 589824
s_add_u32 s67, s67, s68
v_mul_u32_u24 v52, 147456, v3
v_lshl_add_u32 v52, v2, 4, v52
buffer_load_dwordx4 v[64:67], v52, s[24:27], s67 offen nt
s_add_u32 s67, s67, 8192
buffer_load_dwordx4 v[68:71], v52, s[24:27], s67 offen nt
s_add_u32 s67, s67, 8192
buffer_load_dwordx4 v[72:75], v52, s[24:27], s67 offen nt
s_add_u32 s67, s67, 8192
buffer_load_dwordx4 v[76:79], v52, s[24:27], s67 offen nt
s_add_u32 s67, s67, 8192
buffer_load_dwordx4 v[80:83], v52, s[24:27], s67 offen nt
s_add_u32 s67, s67, 8192
buffer_load_dwordx4 v[84:87], v52, s[24:27], s67 offen nt
s_add_u32 s67, s67, 8192
buffer_load_dwordx4 v[88:91], v52, s[24:27], s67 offen nt
s_add_u32 s67, s67, 8192
buffer_load_dwordx4 v[92:95], v52, s[24:27], s67 offen nt
s_add_u32 s67, s67, 8192
buffer_load_dwordx4 v[96:99], v52, s[24:27], s67 offen nt
s_add_u32 s67, s67, 8192
buffer_load_dwordx4 v[100:103], v52, s[24:27], s67 offen nt
s_add_u32 s67, s67, 8192
buffer_load_dwordx4 v[104:107], v52, s[24:27], s67 offen nt
s_add_u32 s67, s67, 8192
buffer_load_dwordx4 v[108:111], v52, s[24:27], s67 offen nt
s_add_u32 s67, s67, 8192
buffer_load_dwordx4 v[112:115], v52, s[24:27], s67 offen nt
s_add_u32 s67, s67, 8192
buffer_load_dwordx4 v[116:119], v52, s[24:27], s67 offen nt
s_add_u32 s67, s67, 8192
buffer_load_dwordx4 v[120:123], v52, s[24:27], s67 offen nt
s_add_u32 s67, s67, 8192
buffer_load_dwordx4 v[124:127], v52, s[24:27], s67 offen nt
s_add_u32 s67, s67, 8192
buffer_load_dwordx4 v[128:131], v52, s[24:27], s67 offen nt
s_add_u32 s67, s67, 8192
buffer_load_dwordx4 v[132:135], v52, s[24:27], s67 offen nt
s_barrier
s_waitcnt vmcnt(18)
s_branch L_masks
L_qphase2:
v_lshlrev_b32 v210, 16, v200
v_and_b32 v211, 0xffff0000, v200
v_lshlrev_b32 v212, 16, v201
v_and_b32 v213, 0xffff0000, v201
v_lshlrev_b32 v214, 16, v202
v_and_b32 v215, 0xffff0000, v202
v_lshlrev_b32 v216, 16, v203
v_and_b32 v217, 0xffff0000, v203
v_lshlrev_b32 v218, 16, v204
v_and_b32 v219, 0xffff0000, v204
v_lshlrev_b32 v220, 16, v205
v_and_b32 v221, 0xffff0000, v205
v_lshlrev_b32 v222, 16, v206
v_and_b32 v223, 0xffff0000, v206
v_lshlrev_b32 v224, 16, v207
v_and_b32 v225, 0xffff0000, v207
v_lshlrev_b32 v226, 16, v208
v_and_b32 v227, 0xffff0000, v208
v_add_f32 v40, v210, v211
v_add_f32 v40, v40, v212
v_add_f32 v40, v40, v213
v_add_f32 v40, v40, v214
v_add_f32 v40, v40, v215
v_add_f32 v40, v40, v216
v_add_f32 v40, v40, v217
v_add_f32 v40, v40, v218
v_add_f32 v40, v40, v219
v_add_f32 v40, v40, v220
v_add_f32 v40, v40, v221
v_add_f32 v40, v40, v222
v_add_f32 v40, v40, v223
v_add_f32 v40, v40, v224
v_add_f32 v40, v40, v225
v_add_f32 v40, v40, v226
v_add_f32 v40, v40, v227
s_nop 1
v_add_f32_dpp v40, v40, v40 row_ror:8 row_mask:0xf bank_mask:0xf
s_nop 1
v_add_f32_dpp v40, v40, v40 row_ror:4 row_mask:0xf bank_mask:0xf
s_nop 1
v_add_f32_dpp v40, v40, v40 row_ror:2 row_mask:0xf bank_mask:0xf
s_nop 1
v_add_f32_dpp v40, v40, v40 row_ror:1 row_mask:0xf bank_mask:0xf
v_mov_b32 v41, v40
s_nop 1
v_permlane16_swap_b32 v40, v41
v_add_f32 v40, v40, v41
v_mul_f32 v40, 0x3ae38e39, v40
v_sub_f32 v210, v210, v40
v_sub_f32 v211, v211, v40
v_sub_f32 v212, v212, v40
v_sub_f32 v213, v213, v40
v_sub_f32 v214, v214, v40
v_sub_f32 v215, v215, v40
v_sub_f32 v216, v216, v40
v_sub_f32 v217, v217, v40
v_sub_f32 v218, v218, v40
v_sub_f32 v219, v219, v40
v_sub_f32 v220, v220, v40
v_sub_f32 v221, v221, v40
v_sub_f32 v222, v222, v40
v_sub_f32 v223, v223, v40
v_sub_f32 v224, v224, v40
v_sub_f32 v225, v225, v40
v_sub_f32 v226, v226, v40
v_sub_f32 v227, v227, v40
v_mul_f32 v40, v210, v210
v_fmac_f32 v40, v211, v211
v_fmac_f32 v40, v212, v212
v_fmac_f32 v40, v213, v213
v_fmac_f32 v40, v214, v214
v_fmac_f32 v40, v215, v215
v_fmac_f32 v40, v216, v216
v_fmac_f32 v40, v217, v217
v_fmac_f32 v40, v218, v218
v_fmac_f32 v40, v219, v219
v_fmac_f32 v40, v220, v220
v_fmac_f32 v40, v221, v221
v_fmac_f32 v40, v222, v222
v_fmac_f32 v40, v223, v223
v_fmac_f32 v40, v224, v224
v_fmac_f32 v40, v225, v225
v_fmac_f32 v40, v226, v226
v_fmac_f32 v40, v227, v227
s_nop 1
v_add_f32_dpp v40, v40, v40 row_ror:8 row_mask:0xf bank_mask:0xf
s_nop 1
v_add_f32_dpp v40, v40, v40 row_ror:4 row_mask:0xf bank_mask:0xf
s_nop 1
v_add_f32_dpp v40, v40, v40 row_ror:2 row_mask:0xf bank_mask:0xf
s_nop 1
v_add_f32_dpp v40, v40, v40 row_ror:1 row_mask:0xf bank_mask:0xf
v_mov_b32 v41, v40
s_nop 1
v_permlane16_swap_b32 v40, v41
v_add_f32 v40, v40, v41
v_mov_b32 v41, 0x3727c5ac
v_fmac_f32 v41, 0x3ae38e39, v40
v_rsq_f32 v40, v41
s_nop 0
v_mul_f32 v210, v210, v40
v_mul_f32 v211, v211, v40
v_mul_f32 v212, v212, v40
v_mul_f32 v213, v213, v40
v_mul_f32 v214, v214, v40
v_mul_f32 v215, v215, v40
v_mul_f32 v216, v216, v40
v_mul_f32 v217, v217, v40
v_mul_f32 v218, v218, v40
v_mul_f32 v219, v219, v40
v_mul_f32 v220, v220, v40
v_mul_f32 v221, v221, v40
v_mul_f32 v222, v222, v40
v_mul_f32 v223, v223, v40
v_mul_f32 v224, v224, v40
v_mul_f32 v225, v225, v40
v_mul_f32 v226, v226, v40
v_mul_f32 v227, v227, v40
v_cvt_pk_bf16_f32 v200, v210, v211
v_cvt_pk_bf16_f32 v201, v212, v213
v_cvt_pk_bf16_f32 v202, v214, v215
v_cvt_pk_bf16_f32 v203, v216, v217
v_cvt_pk_bf16_f32 v204, v218, v219
v_cvt_pk_bf16_f32 v205, v220, v221
v_cvt_pk_bf16_f32 v206, v222, v223
v_cvt_pk_bf16_f32 v207, v224, v225
v_cvt_pk_bf16_f32 v208, v226, v227
ds_write_b128 v51, v[200:203] offset:0
ds_write_b128 v51, v[204:207] offset:512
ds_write_b32 v50, v208 offset:1024
v_lshrrev_b32 v48, 3, v2
v_mul_u32_u24 v48, 1152, v48
v_mul_u32_u24 v49, 36, v3
s_mul_i32 s67, s64, 144
v_add3_u32 v48, v48, v49, s67
v_mov_b32 v49, 32
v_mov_b32 v54, 0
ds_write_b32 v54, v49 offset:3072
v_mov_b32 v56, 0
v_mov_b32 v57, 0
v_mov_b32 v58, 0
v_mov_b32 v59, 0

s_waitcnt lgkmcnt(0)
ds_read_b32 v200, v48 offset:0
ds_read_b32 v201, v48 offset:4
ds_read_b32 v202, v48 offset:8
ds_read_b32 v203, v48 offset:12
ds_read_b32 v204, v48 offset:16
ds_read_b32 v205, v48 offset:20
ds_read_b32 v206, v48 offset:24
ds_read_b32 v207, v48 offset:28
ds_read_b32 v208, v48 offset:32
s_mov_b32 s68, 0x01000100
s_mov_b32 s69, 0x03020302
s_waitcnt vmcnt(0) lgkmcnt(0)
v_perm_b32 v55, v200, v200, s68
v_and_b32 v40, v6, v55
v_and_b32 v41, v7, v55
v_and_b32 v42, v8, v55
v_and_b32 v43, v9, v55
v_perm_b32 v55, v200, v200, s69
v_and_b32 v44, v6, v55
v_and_b32 v45, v7, v55
v_and_b32 v46, v8, v55
v_and_b32 v47, v9, v55
v_mfma_f32_16x16x32_bf16 v[26:29], v[64:67], v[40:43], 0
v_perm_b32 v55, v201, v201, s68
v_and_b32 v40, v6, v55
v_and_b32 v41, v7, v55
v_and_b32 v42, v8, v55
v_and_b32 v43, v9, v55
v_mfma_f32_16x16x32_bf16 v[26:29], v[68:71], v[44:47], v[26:29]
v_perm_b32 v55, v201, v201, s69
v_and_b32 v44, v6, v55
v_and_b32 v45, v7, v55
v_and_b32 v46, v8, v55
v_and_b32 v47, v9, v55
v_mfma_f32_16x16x32_bf16 v[26:29], v[72:75], v[40:43], v[26:29]
v_perm_b32 v55, v202, v202, s68
v_and_b32 v40, v6, v55
v_and_b32 v41, v7, v55
v_and_b32 v42, v8, v55
v_and_b32 v43, v9, v55
v_mfma_f32_16x16x32_bf16 v[26:29], v[76:79], v[44:47], v[26:29]
v_perm_b32 v55, v202, v202, s69
v_and_b32 v44, v6, v55
v_and_b32 v45, v7, v55
v_and_b32 v46, v8, v55
v_and_b32 v47, v9, v55
v_mfma_f32_16x16x32_bf16 v[26:29], v[80:83], v[40:43], v[26:29]
v_perm_b32 v55, v203, v203, s68
v_and_b32 v40, v6, v55
v_and_b32 v41, v7, v55
v_and_b32 v42, v8, v55
v_and_b32 v43, v9, v55
v_mfma_f32_16x16x32_bf16 v[26:29], v[84:87], v[44:47], v[26:29]
v_perm_b32 v55, v203, v203, s69
v_and_b32 v44, v6, v55
v_and_b32 v45, v7, v55
v_and_b32 v46, v8, v55
v_and_b32 v47, v9, v55
v_mfma_f32_16x16x32_bf16 v[26:29], v[88:91], v[40:43], v[26:29]
v_perm_b32 v55, v204, v204, s68
v_and_b32 v40, v6, v55
v_and_b32 v41, v7, v55
v_and_b32 v42, v8, v55
v_and_b32 v43, v9, v55
v_mfma_f32_16x16x32_bf16 v[26:29], v[92:95], v[44:47], v[26:29]
v_perm_b32 v55, v204, v204, s69
v_and_b32 v44, v6, v55
v_and_b32 v45, v7, v55
v_and_b32 v46, v8, v55
v_and_b32 v47, v9, v55
v_mfma_f32_16x16x32_bf16 v[26:29], v[96:99], v[40:43], v[26:29]
v_perm_b32 v55, v205, v205, s68
v_and_b32 v40, v6, v55
v_and_b32 v41, v7, v55
v_and_b32 v42, v8, v55
v_and_b32 v43, v9, v55
v_mfma_f32_16x16x32_bf16 v[26:29], v[100:103], v[44:47], v[26:29]
v_perm_b32 v55, v205, v205, s69
v_and_b32 v44, v6, v55
v_and_b32 v45, v7, v55
v_and_b32 v46, v8, v55
v_and_b32 v47, v9, v55
v_mfma_f32_16x16x32_bf16 v[26:29], v[104:107], v[40:43], v[26:29]
v_perm_b32 v55, v206, v206, s68
v_and_b32 v40, v6, v55
v_and_b32 v41, v7, v55
v_and_b32 v42, v8, v55
v_and_b32 v43, v9, v55
v_mfma_f32_16x16x32_bf16 v[26:29], v[108:111], v[44:47], v[26:29]
v_perm_b32 v55, v206, v206, s69
v_and_b32 v44, v6, v55
v_and_b32 v45, v7, v55
v_and_b32 v46, v8, v55
v_and_b32 v47, v9, v55
v_mfma_f32_16x16x32_bf16 v[26:29], v[112:115], v[40:43], v[26:29]
v_perm_b32 v55, v207, v207, s68
v_and_b32 v40, v6, v55
v_and_b32 v41, v7, v55
v_and_b32 v42, v8, v55
v_and_b32 v43, v9, v55
v_mfma_f32_16x16x32_bf16 v[26:29], v[116:119], v[44:47], v[26:29]
v_perm_b32 v55, v207, v207, s69
v_and_b32 v44, v6, v55
v_and_b32 v45, v7, v55
v_and_b32 v46, v8, v55
v_and_b32 v47, v9, v55
v_mfma_f32_16x16x32_bf16 v[26:29], v[120:123], v[40:43], v[26:29]
v_perm_b32 v55, v208, v208, s68
v_and_b32 v40, v6, v55
v_and_b32 v41, v7, v55
v_and_b32 v42, v8, v55
v_and_b32 v43, v9, v55
v_mfma_f32_16x16x32_bf16 v[26:29], v[124:127], v[44:47], v[26:29]
v_perm_b32 v55, v208, v208, s69
v_and_b32 v44, v6, v55
v_and_b32 v45, v7, v55
v_and_b32 v46, v8, v55
v_and_b32 v47, v9, v55
v_mfma_f32_16x16x32_bf16 v[26:29], v[128:131], v[40:43], v[26:29]
s_nop 1
v_mfma_f32_16x16x32_bf16 v[26:29], v[132:135], v[44:47], v[26:29]
v_lshrrev_b32 v48, 3, v2
v_lshlrev_b32 v48, 13, v48
v_and_b32 v49, 7, v2
v_lshl_add_u32 v49, v3, 3, v49
v_lshl_add_u32 v48, v49, 4, v48
s_lshl_b32 s67, s62, 14
s_lshl_b32 s68, s63, 12
s_add_u32 s67, s67, s68
s_lshl_b32 s68, s64, 9
s_add_u32 s67, s67, s68
s_nop 0
s_mov_b32 s68, 0x07060501
s_mov_b32 s69, 0x07060502
s_mov_b32 s79, 0x07060503
v_perm_b32 v26, v26, v29, s68
v_perm_b32 v27, v27, v29, s69
v_perm_b32 v28, v28, v29, s79
v_mov_b32 v29, s80
buffer_store_dwordx4 v[26:29], v48, s[12:15], s67 offen sc1
v_lshrrev_b32 v48, 5, v1
v_and_b32 v49, 31, v1
v_lshlrev_b32 v50, 12, v48
v_lshl_add_u32 v50, v49, 4, v50
s_lshl_b32 s67, s62, 14
s_lshl_b32 s68, s63, 13
s_add_u32 s67, s67, s68
v_lshrrev_b32 v51, 3, v49
v_lshlrev_b32 v51, 6, v51
v_and_b32 v49, 7, v49
v_lshl_add_u32 v51, v49, 1, v51
v_lshl_add_u32 v51, v48, 8, v51
s_mov_b32 s68, 0x0c0c0400
s_mov_b32 s69, 0x0401000c
s_mov_b32 s70, 262144
L_qpoll:
buffer_load_dwordx4 v[64:67], v50, s[12:15], s67 offen offset:0 sc1
buffer_load_dwordx4 v[68:71], v50, s[12:15], s67 offen offset:512 sc1
buffer_load_dwordx4 v[72:75], v50, s[12:15], s67 offen offset:1024 sc1
buffer_load_dwordx4 v[76:79], v50, s[12:15], s67 offen offset:1536 sc1
buffer_load_dwordx4 v[80:83], v50, s[12:15], s67 offen offset:2048 sc1
buffer_load_dwordx4 v[84:87], v50, s[12:15], s67 offen offset:2560 sc1
buffer_load_dwordx4 v[88:91], v50, s[12:15], s67 offen offset:3072 sc1
buffer_load_dwordx4 v[92:95], v50, s[12:15], s67 offen offset:3584 sc1
s_waitcnt vmcnt(0)
v_xor_b32 v38, s80, v67
v_xor_b32 v39, s80, v71
v_or_b32 v38, v38, v39
v_xor_b32 v39, s80, v75
v_or_b32 v38, v38, v39
v_xor_b32 v39, s80, v79
v_or_b32 v38, v38, v39
v_xor_b32 v39, s80, v83
v_or_b32 v38, v38, v39
v_xor_b32 v39, s80, v87
v_or_b32 v38, v38, v39
v_xor_b32 v39, s80, v91
v_or_b32 v38, v38, v39
v_xor_b32 v39, s80, v95
v_or_b32 v38, v38, v39
v_cmp_ne_u32 vcc, 0, v38
s_cbranch_vccz L_qgot
s_sub_u32 s70, s70, 1
s_cbranch_scc0 L_qpoll
L_qgot:
v_perm_b32 v67, v65, v64, s68
v_perm_b32 v67, v66, v67, s69
v_perm_b32 v71, v69, v68, s68
v_perm_b32 v71, v70, v71, s69
v_perm_b32 v75, v73, v72, s68
v_perm_b32 v75, v74, v75, s69
v_perm_b32 v79, v77, v76, s68
v_perm_b32 v79, v78, v79, s69
v_perm_b32 v83, v81, v80, s68
v_perm_b32 v83, v82, v83, s69
v_perm_b32 v87, v85, v84, s68
v_perm_b32 v87, v86, v87, s69
v_perm_b32 v91, v89, v88, s68
v_perm_b32 v91, v90, v91, s69
v_perm_b32 v95, v93, v92, s68
v_perm_b32 v95, v94, v95, s69
v_add_f32 v64, v64, v68
v_add_f32 v65, v65, v69
v_add_f32 v66, v66, v70
v_add_f32 v67, v67, v71
v_add_f32 v64, v64, v72
v_add_f32 v65, v65, v73
v_add_f32 v66, v66, v74
v_add_f32 v67, v67, v75
v_add_f32 v64, v64, v76
v_add_f32 v65, v65, v77
v_add_f32 v66, v66, v78
v_add_f32 v67, v67, v79
v_add_f32 v64, v64, v80
v_add_f32 v65, v65, v81
v_add_f32 v66, v66, v82
v_add_f32 v67, v67, v83
v_add_f32 v64, v64, v84
v_add_f32 v65, v65, v85
v_add_f32 v66, v66, v86
v_add_f32 v67, v67, v87
v_add_f32 v64, v64, v88
v_add_f32 v65, v65, v89
v_add_f32 v66, v66, v90
v_add_f32 v67, v67, v91
v_add_f32 v64, v64, v92
v_add_f32 v65, v65, v93
v_add_f32 v66, v66, v94
v_add_f32 v67, v67, v95
v_cvt_pk_bf16_f32 v64, v64, v64
v_cvt_pk_bf16_f32 v65, v65, v65
v_cvt_pk_bf16_f32 v66, v66, v66
v_cvt_pk_bf16_f32 v67, v67, v67
ds_write_b16 v51, v64 offset:2560
ds_write_b16 v51, v65 offset:2576
ds_write_b16 v51, v66 offset:2592
ds_write_b16 v51, v67 offset:2608
s_waitcnt lgkmcnt(0)
s_barrier
s_lshl_b32 s67, s3, 12
s_add_u32 s67, s67, s66
buffer_load_dwordx4 v[64:67], v4, s[4:7], s67 offen offset:0 nt
buffer_load_dwordx4 v[68:71], v4, s[4:7], s67 offen offset:64 nt
buffer_load_dwordx4 v[72:75], v4, s[4:7], s67 offen offset:128 nt
buffer_load_dwordx4 v[76:79], v4, s[4:7], s67 offen offset:192 nt
buffer_load_dwordx4 v[80:83], v5, s[8:11], s67 offen offset:0 nt
buffer_load_dwordx4 v[84:87], v5, s[8:11], s67 offen offset:256 nt
buffer_load_dwordx4 v[88:91], v5, s[8:11], s67 offen offset:512 nt
buffer_load_dwordx4 v[92:95], v5, s[8:11], s67 offen offset:768 nt
s_add_u32 s67, s67, 32768
buffer_load_dwordx4 v[96:99], v4, s[4:7], s67 offen offset:0 nt
buffer_load_dwordx4 v[100:103], v4, s[4:7], s67 offen offset:64 nt
buffer_load_dwordx4 v[104:107], v4, s[4:7], s67 offen offset:128 nt
buffer_load_dwordx4 v[108:111], v4, s[4:7], s67 offen offset:192 nt
buffer_load_dwordx4 v[112:115], v5, s[8:11], s67 offen offset:0 nt
buffer_load_dwordx4 v[116:119], v5, s[8:11], s67 offen offset:256 nt
buffer_load_dwordx4 v[120:123], v5, s[8:11], s67 offen offset:512 nt
buffer_load_dwordx4 v[124:127], v5, s[8:11], s67 offen offset:768 nt
s_add_u32 s67, s67, 32768
buffer_load_dwordx4 v[128:131], v4, s[4:7], s67 offen offset:0 nt
buffer_load_dwordx4 v[132:135], v4, s[4:7], s67 offen offset:64 nt
buffer_load_dwordx4 v[136:139], v4, s[4:7], s67 offen offset:128 nt
buffer_load_dwordx4 v[140:143], v4, s[4:7], s67 offen offset:192 nt
buffer_load_dwordx4 v[144:147], v5, s[8:11], s67 offen offset:0 nt
buffer_load_dwordx4 v[148:151], v5, s[8:11], s67 offen offset:256 nt
buffer_load_dwordx4 v[152:155], v5, s[8:11], s67 offen offset:512 nt
buffer_load_dwordx4 v[156:159], v5, s[8:11], s67 offen offset:768 nt
s_add_u32 s67, s67, 32768
buffer_load_dwordx4 v[160:163], v4, s[4:7], s67 offen offset:0 nt
buffer_load_dwordx4 v[164:167], v4, s[4:7], s67 offen offset:64 nt
buffer_load_dwordx4 v[168:171], v4, s[4:7], s67 offen offset:128 nt
buffer_load_dwordx4 v[172:175], v4, s[4:7], s67 offen offset:192 nt
buffer_load_dwordx4 v[176:179], v5, s[8:11], s67 offen offset:0 nt
buffer_load_dwordx4 v[180:183], v5, s[8:11], s67 offen offset:256 nt
buffer_load_dwordx4 v[184:187], v5, s[8:11], s67 offen offset:512 nt
buffer_load_dwordx4 v[188:191], v5, s[8:11], s67 offen offset:768 nt
L_main:
v_lshrrev_b32 v48, 3, v2
v_lshlrev_b32 v48, 8, v48
v_lshl_add_u32 v48, v3, 4, v48
ds_read_b128 v[10:13], v48 offset:2560
ds_read_b128 v[14:17], v48 offset:2624
ds_read_b128 v[18:21], v48 offset:2688
ds_read_b128 v[22:25], v48 offset:2752
v_mov_b32 v26, 0
v_mov_b32 v27, 0
v_mov_b32 v28, 0
v_mov_b32 v29, 0
v_mov_b32 v30, 0xff800000
v_mov_b32 v31, 0
v_mov_b32 v52, 3072
v_mov_b32 v55, 1
s_mov_b32 s71, 4
s_waitcnt lgkmcnt(0)
L_loop:
s_waitcnt vmcnt(24)
v_mfma_f32_16x16x32_bf16 v[32:35], v[64:67], v[10:13], 0
v_mfma_f32_16x16x32_bf16 v[32:35], v[68:71], v[14:17], v[32:35]
v_mfma_f32_16x16x32_bf16 v[32:35], v[72:75], v[18:21], v[32:35]
v_mfma_f32_16x16x32_bf16 v[32:35], v[76:79], v[22:25], v[32:35]
s_mov_b64 exec, 1
ds_add_rtn_u32 v54, v52, v55
s_mov_b64 exec, -1
s_nop 4
v_max3_f32 v36, v32, v33, v34
v_max_f32 v36, v36, v35
v_mov_b32 v37, v36
s_nop 1
v_permlane16_swap_b32 v36, v37
v_max_f32 v36, v36, v37
v_mov_b32 v37, v36
s_nop 1
v_permlane32_swap_b32 v36, v37
v_max_f32 v36, v36, v37
v_max_f32 v36, v36, v30
v_mul_f32 v37, s77, v36
v_fma_f32 v38, v30, s76, v37
v_fma_f32 v32, v32, s76, v37
v_exp_f32 v38, v38
v_exp_f32 v32, v32
v_fma_f32 v33, v33, s76, v37
v_fma_f32 v34, v34, s76, v37
v_fma_f32 v35, v35, s76, v37
v_mov_b32 v30, v36
v_cvt_pk_bf16_f32 v39, v32, v32
v_exp_f32 v33, v33
v_exp_f32 v34, v34
v_exp_f32 v35, v35
v_mul_f32 v26, v26, v38
v_mul_f32 v27, v27, v38
v_mul_f32 v28, v28, v38
v_mul_f32 v29, v29, v38
v_fma_f32 v31, v31, v38, v32
v_and_b32 v40, v6, v39
v_and_b32 v41, v7, v39
v_and_b32 v42, v8, v39
v_and_b32 v43, v9, v39
v_cvt_pk_bf16_f32 v39, v33, v33
v_add_f32 v31, v31, v33
v_mfma_f32_16x16x32_bf16 v[26:29], v[80:83], v[40:43], v[26:29]
v_and_b32 v44, v6, v39
v_and_b32 v45, v7, v39
v_and_b32 v46, v8, v39
v_and_b32 v47, v9, v39
v_cvt_pk_bf16_f32 v39, v34, v34
v_add_f32 v31, v31, v34
v_mfma_f32_16x16x32_bf16 v[26:29], v[84:87], v[44:47], v[26:29]
v_and_b32 v40, v6, v39
v_and_b32 v41, v7, v39
v_and_b32 v42, v8, v39
v_and_b32 v43, v9, v39
v_cvt_pk_bf16_f32 v39, v35, v35
v_add_f32 v31, v31, v35
v_mfma_f32_16x16x32_bf16 v[26:29], v[88:91], v[40:43], v[26:29]
v_and_b32 v44, v6, v39
v_and_b32 v45, v7, v39
v_and_b32 v46, v8, v39
v_and_b32 v47, v9, v39
s_waitcnt lgkmcnt(0)
v_readfirstlane_b32 s67, v54
v_mfma_f32_16x16x32_bf16 v[26:29], v[92:95], v[44:47], v[26:29]
s_cmp_ge_u32 s67, 256
s_cbranch_scc1 L_skip1
s_lshl_b32 s67, s67, 12
s_add_u32 s67, s67, s66
buffer_load_dwordx4 v[64:67], v4, s[4:7], s67 offen offset:0 nt
buffer_load_dwordx4 v[68:71], v4, s[4:7], s67 offen offset:64 nt
buffer_load_dwordx4 v[72:75], v4, s[4:7], s67 offen offset:128 nt
buffer_load_dwordx4 v[76:79], v4, s[4:7], s67 offen offset:192 nt
buffer_load_dwordx4 v[80:83], v5, s[8:11], s67 offen offset:0 nt
buffer_load_dwordx4 v[84:87], v5, s[8:11], s67 offen offset:256 nt
buffer_load_dwordx4 v[88:91], v5, s[8:11], s67 offen offset:512 nt
buffer_load_dwordx4 v[92:95], v5, s[8:11], s67 offen offset:768 nt
s_branch L_next2
L_skip1:
s_sub_u32 s71, s71, 1
s_cmp_eq_u32 s71, 0
s_cbranch_scc1 L_tail
s_cmp_lg_u32 s71, 3
s_cbranch_scc1 L_dr3
s_waitcnt vmcnt(16)
s_branch L_next2
L_dr3:
s_cmp_lg_u32 s71, 2
s_cbranch_scc1 L_dr4
s_waitcnt vmcnt(8)
s_branch L_next2
L_dr4:
s_waitcnt vmcnt(0)
L_next2:
s_waitcnt vmcnt(24)
v_mfma_f32_16x16x32_bf16 v[32:35], v[96:99], v[10:13], 0
v_mfma_f32_16x16x32_bf16 v[32:35], v[100:103], v[14:17], v[32:35]
v_mfma_f32_16x16x32_bf16 v[32:35], v[104:107], v[18:21], v[32:35]
v_mfma_f32_16x16x32_bf16 v[32:35], v[108:111], v[22:25], v[32:35]
s_mov_b64 exec, 1
ds_add_rtn_u32 v54, v52, v55
s_mov_b64 exec, -1
s_nop 4
v_max3_f32 v36, v32, v33, v34
v_max_f32 v36, v36, v35
v_mov_b32 v37, v36
s_nop 1
v_permlane16_swap_b32 v36, v37
v_max_f32 v36, v36, v37
v_mov_b32 v37, v36
s_nop 1
v_permlane32_swap_b32 v36, v37
v_max_f32 v36, v36, v37
v_max_f32 v36, v36, v30
v_mul_f32 v37, s77, v36
v_fma_f32 v38, v30, s76, v37
v_fma_f32 v32, v32, s76, v37
v_exp_f32 v38, v38
v_exp_f32 v32, v32
v_fma_f32 v33, v33, s76, v37
v_fma_f32 v34, v34, s76, v37
v_fma_f32 v35, v35, s76, v37
v_mov_b32 v30, v36
v_cvt_pk_bf16_f32 v39, v32, v32
v_exp_f32 v33, v33
v_exp_f32 v34, v34
v_exp_f32 v35, v35
v_mul_f32 v26, v26, v38
v_mul_f32 v27, v27, v38
v_mul_f32 v28, v28, v38
v_mul_f32 v29, v29, v38
v_fma_f32 v31, v31, v38, v32
v_and_b32 v40, v6, v39
v_and_b32 v41, v7, v39
v_and_b32 v42, v8, v39
v_and_b32 v43, v9, v39
v_cvt_pk_bf16_f32 v39, v33, v33
v_add_f32 v31, v31, v33
v_mfma_f32_16x16x32_bf16 v[26:29], v[112:115], v[40:43], v[26:29]
v_and_b32 v44, v6, v39
v_and_b32 v45, v7, v39
v_and_b32 v46, v8, v39
v_and_b32 v47, v9, v39
v_cvt_pk_bf16_f32 v39, v34, v34
v_add_f32 v31, v31, v34
v_mfma_f32_16x16x32_bf16 v[26:29], v[116:119], v[44:47], v[26:29]
v_and_b32 v40, v6, v39
v_and_b32 v41, v7, v39
v_and_b32 v42, v8, v39
v_and_b32 v43, v9, v39
v_cvt_pk_bf16_f32 v39, v35, v35
v_add_f32 v31, v31, v35
v_mfma_f32_16x16x32_bf16 v[26:29], v[120:123], v[40:43], v[26:29]
v_and_b32 v44, v6, v39
v_and_b32 v45, v7, v39
v_and_b32 v46, v8, v39
v_and_b32 v47, v9, v39
s_waitcnt lgkmcnt(0)
v_readfirstlane_b32 s67, v54
v_mfma_f32_16x16x32_bf16 v[26:29], v[124:127], v[44:47], v[26:29]
s_cmp_ge_u32 s67, 256
s_cbranch_scc1 L_skip6
s_lshl_b32 s67, s67, 12
s_add_u32 s67, s67, s66
buffer_load_dwordx4 v[96:99], v4, s[4:7], s67 offen offset:0 nt
buffer_load_dwordx4 v[100:103], v4, s[4:7], s67 offen offset:64 nt
buffer_load_dwordx4 v[104:107], v4, s[4:7], s67 offen offset:128 nt
buffer_load_dwordx4 v[108:111], v4, s[4:7], s67 offen offset:192 nt
buffer_load_dwordx4 v[112:115], v5, s[8:11], s67 offen offset:0 nt
buffer_load_dwordx4 v[116:119], v5, s[8:11], s67 offen offset:256 nt
buffer_load_dwordx4 v[120:123], v5, s[8:11], s67 offen offset:512 nt
buffer_load_dwordx4 v[124:127], v5, s[8:11], s67 offen offset:768 nt
s_branch L_next7
L_skip6:
s_sub_u32 s71, s71, 1
s_cmp_eq_u32 s71, 0
s_cbranch_scc1 L_tail
s_cmp_lg_u32 s71, 3
s_cbranch_scc1 L_dr8
s_waitcnt vmcnt(16)
s_branch L_next7
L_dr8:
s_cmp_lg_u32 s71, 2
s_cbranch_scc1 L_dr9
s_waitcnt vmcnt(8)
s_branch L_next7
L_dr9:
s_waitcnt vmcnt(0)
L_next7:
s_waitcnt vmcnt(24)
v_mfma_f32_16x16x32_bf16 v[32:35], v[128:131], v[10:13], 0
v_mfma_f32_16x16x32_bf16 v[32:35], v[132:135], v[14:17], v[32:35]
v_mfma_f32_16x16x32_bf16 v[32:35], v[136:139], v[18:21], v[32:35]
v_mfma_f32_16x16x32_bf16 v[32:35], v[140:143], v[22:25], v[32:35]
s_mov_b64 exec, 1
ds_add_rtn_u32 v54, v52, v55
s_mov_b64 exec, -1
s_nop 4
v_max3_f32 v36, v32, v33, v34
v_max_f32 v36, v36, v35
v_mov_b32 v37, v36
s_nop 1
v_permlane16_swap_b32 v36, v37
v_max_f32 v36, v36, v37
v_mov_b32 v37, v36
s_nop 1
v_permlane32_swap_b32 v36, v37
v_max_f32 v36, v36, v37
v_max_f32 v36, v36, v30
v_mul_f32 v37, s77, v36
v_fma_f32 v38, v30, s76, v37
v_fma_f32 v32, v32, s76, v37
v_exp_f32 v38, v38
v_exp_f32 v32, v32
v_fma_f32 v33, v33, s76, v37
v_fma_f32 v34, v34, s76, v37
v_fma_f32 v35, v35, s76, v37
v_mov_b32 v30, v36
v_cvt_pk_bf16_f32 v39, v32, v32
v_exp_f32 v33, v33
v_exp_f32 v34, v34
v_exp_f32 v35, v35
v_mul_f32 v26, v26, v38
v_mul_f32 v27, v27, v38
v_mul_f32 v28, v28, v38
v_mul_f32 v29, v29, v38
v_fma_f32 v31, v31, v38, v32
v_and_b32 v40, v6, v39
v_and_b32 v41, v7, v39
v_and_b32 v42, v8, v39
v_and_b32 v43, v9, v39
v_cvt_pk_bf16_f32 v39, v33, v33
v_add_f32 v31, v31, v33
v_mfma_f32_16x16x32_bf16 v[26:29], v[144:147], v[40:43], v[26:29]
v_and_b32 v44, v6, v39
v_and_b32 v45, v7, v39
v_and_b32 v46, v8, v39
v_and_b32 v47, v9, v39
v_cvt_pk_bf16_f32 v39, v34, v34
v_add_f32 v31, v31, v34
v_mfma_f32_16x16x32_bf16 v[26:29], v[148:151], v[44:47], v[26:29]
v_and_b32 v40, v6, v39
v_and_b32 v41, v7, v39
v_and_b32 v42, v8, v39
v_and_b32 v43, v9, v39
v_cvt_pk_bf16_f32 v39, v35, v35
v_add_f32 v31, v31, v35
v_mfma_f32_16x16x32_bf16 v[26:29], v[152:155], v[40:43], v[26:29]
v_and_b32 v44, v6, v39
v_and_b32 v45, v7, v39
v_and_b32 v46, v8, v39
v_and_b32 v47, v9, v39
s_waitcnt lgkmcnt(0)
v_readfirstlane_b32 s67, v54
v_mfma_f32_16x16x32_bf16 v[26:29], v[156:159], v[44:47], v[26:29]
s_cmp_ge_u32 s67, 256
s_cbranch_scc1 L_skip11
s_lshl_b32 s67, s67, 12
s_add_u32 s67, s67, s66
buffer_load_dwordx4 v[128:131], v4, s[4:7], s67 offen offset:0 nt
buffer_load_dwordx4 v[132:135], v4, s[4:7], s67 offen offset:64 nt
buffer_load_dwordx4 v[136:139], v4, s[4:7], s67 offen offset:128 nt
buffer_load_dwordx4 v[140:143], v4, s[4:7], s67 offen offset:192 nt
buffer_load_dwordx4 v[144:147], v5, s[8:11], s67 offen offset:0 nt
buffer_load_dwordx4 v[148:151], v5, s[8:11], s67 offen offset:256 nt
buffer_load_dwordx4 v[152:155], v5, s[8:11], s67 offen offset:512 nt
buffer_load_dwordx4 v[156:159], v5, s[8:11], s67 offen offset:768 nt
s_branch L_next12
L_skip11:
s_sub_u32 s71, s71, 1
s_cmp_eq_u32 s71, 0
s_cbranch_scc1 L_tail
s_cmp_lg_u32 s71, 3
s_cbranch_scc1 L_dr13
s_waitcnt vmcnt(16)
s_branch L_next12
L_dr13:
s_cmp_lg_u32 s71, 2
s_cbranch_scc1 L_dr14
s_waitcnt vmcnt(8)
s_branch L_next12
L_dr14:
s_waitcnt vmcnt(0)
L_next12:
s_waitcnt vmcnt(24)
v_mfma_f32_16x16x32_bf16 v[32:35], v[160:163], v[10:13], 0
v_mfma_f32_16x16x32_bf16 v[32:35], v[164:167], v[14:17], v[32:35]
v_mfma_f32_16x16x32_bf16 v[32:35], v[168:171], v[18:21], v[32:35]
v_mfma_f32_16x16x32_bf16 v[32:35], v[172:175], v[22:25], v[32:35]
s_mov_b64 exec, 1
ds_add_rtn_u32 v54, v52, v55
s_mov_b64 exec, -1
s_nop 4
v_max3_f32 v36, v32, v33, v34
v_max_f32 v36, v36, v35
v_mov_b32 v37, v36
s_nop 1
v_permlane16_swap_b32 v36, v37
v_max_f32 v36, v36, v37
v_mov_b32 v37, v36
s_nop 1
v_permlane32_swap_b32 v36, v37
v_max_f32 v36, v36, v37
v_max_f32 v36, v36, v30
v_mul_f32 v37, s77, v36
v_fma_f32 v38, v30, s76, v37
v_fma_f32 v32, v32, s76, v37
v_exp_f32 v38, v38
v_exp_f32 v32, v32
v_fma_f32 v33, v33, s76, v37
v_fma_f32 v34, v34, s76, v37
v_fma_f32 v35, v35, s76, v37
v_mov_b32 v30, v36
v_cvt_pk_bf16_f32 v39, v32, v32
v_exp_f32 v33, v33
v_exp_f32 v34, v34
v_exp_f32 v35, v35
v_mul_f32 v26, v26, v38
v_mul_f32 v27, v27, v38
v_mul_f32 v28, v28, v38
v_mul_f32 v29, v29, v38
v_fma_f32 v31, v31, v38, v32
v_and_b32 v40, v6, v39
v_and_b32 v41, v7, v39
v_and_b32 v42, v8, v39
v_and_b32 v43, v9, v39
v_cvt_pk_bf16_f32 v39, v33, v33
v_add_f32 v31, v31, v33
v_mfma_f32_16x16x32_bf16 v[26:29], v[176:179], v[40:43], v[26:29]
v_and_b32 v44, v6, v39
v_and_b32 v45, v7, v39
v_and_b32 v46, v8, v39
v_and_b32 v47, v9, v39
v_cvt_pk_bf16_f32 v39, v34, v34
v_add_f32 v31, v31, v34
v_mfma_f32_16x16x32_bf16 v[26:29], v[180:183], v[44:47], v[26:29]
v_and_b32 v40, v6, v39
v_and_b32 v41, v7, v39
v_and_b32 v42, v8, v39
v_and_b32 v43, v9, v39
v_cvt_pk_bf16_f32 v39, v35, v35
v_add_f32 v31, v31, v35
v_mfma_f32_16x16x32_bf16 v[26:29], v[184:187], v[40:43], v[26:29]
v_and_b32 v44, v6, v39
v_and_b32 v45, v7, v39
v_and_b32 v46, v8, v39
v_and_b32 v47, v9, v39
s_waitcnt lgkmcnt(0)
v_readfirstlane_b32 s67, v54
v_mfma_f32_16x16x32_bf16 v[26:29], v[188:191], v[44:47], v[26:29]
s_cmp_ge_u32 s67, 256
s_cbranch_scc1 L_skip16
s_lshl_b32 s67, s67, 12
s_add_u32 s67, s67, s66
buffer_load_dwordx4 v[160:163], v4, s[4:7], s67 offen offset:0 nt
buffer_load_dwordx4 v[164:167], v4, s[4:7], s67 offen offset:64 nt
buffer_load_dwordx4 v[168:171], v4, s[4:7], s67 offen offset:128 nt
buffer_load_dwordx4 v[172:175], v4, s[4:7], s67 offen offset:192 nt
buffer_load_dwordx4 v[176:179], v5, s[8:11], s67 offen offset:0 nt
buffer_load_dwordx4 v[180:183], v5, s[8:11], s67 offen offset:256 nt
buffer_load_dwordx4 v[184:187], v5, s[8:11], s67 offen offset:512 nt
buffer_load_dwordx4 v[188:191], v5, s[8:11], s67 offen offset:768 nt
s_branch L_loop
L_skip16:
s_sub_u32 s71, s71, 1
s_cmp_eq_u32 s71, 0
s_cbranch_scc1 L_tail
s_cmp_lg_u32 s71, 3
s_cbranch_scc1 L_dr18
s_waitcnt vmcnt(16)
s_branch L_loop
L_dr18:
s_cmp_lg_u32 s71, 2
s_cbranch_scc1 L_dr19
s_waitcnt vmcnt(8)
s_branch L_loop
L_dr19:
s_waitcnt vmcnt(0)
s_branch L_loop
L_tail:
s_cmp_gt_u32 s3, 4
s_cbranch_scc1 L_wo21
s_mov_b32 s20, s44
s_and_b32 s21, s45, 0xffff
s_mov_b32 s22, 4718592
s_mov_b32 s23, 0x20000
s_lshl_b32 s67, s62, 8
s_lshl_b32 s68, s63, 7
s_add_u32 s67, s67, s68
s_add_u32 s67, s67, s64
s_mul_i32 s67, s67, 1152
s_lshl_b32 s68, s3, 8
s_add_u32 s67, s67, s68
v_mul_u32_u24 v48, 36864, v3
v_lshl_add_u32 v48, v2, 4, v48
buffer_load_dwordx4 v[64:67], v48, s[20:23], s67 offen nt
s_add_u32 s67, s67, 9216
buffer_load_dwordx4 v[68:71], v48, s[20:23], s67 offen nt
s_add_u32 s67, s67, 9216
buffer_load_dwordx4 v[72:75], v48, s[20:23], s67 offen nt
s_add_u32 s67, s67, 9216
buffer_load_dwordx4 v[76:79], v48, s[20:23], s67 offen nt
L_wo21:
v_mov_b32 v37, v31
s_nop 1
v_permlane16_swap_b32 v31, v37
v_add_f32 v31, v31, v37
v_mov_b32 v37, v31
s_nop 1
v_permlane32_swap_b32 v31, v37
v_add_f32 v31, v31, v37
v_mul_f32 v30, s76, v30
s_lshl_b32 s67, s3, 9
v_lshl_add_u32 v54, v1, 3, s67
v_lshlrev_b32 v55, 1, v54
ds_write_b64 v54, v[30:31] offset:12288
ds_write_b128 v55, v[26:29] offset:4096
v_lshrrev_b32 v52, 1, v1
v_lshlrev_b32 v52, 13, v52
v_and_b32 v53, 1, v1
v_lshl_add_u32 v52, v53, 4, v52
s_waitcnt lgkmcnt(0)
s_barrier
s_cmp_eq_u32 s3, 5
s_cbranch_scc1 L_w5
s_cmp_eq_u32 s3, 6
s_cbranch_scc1 L_w6
s_cmp_eq_u32 s3, 7
s_cbranch_scc1 L_w7
s_cmp_lg_u32 s3, 0
s_cbranch_scc1 L_h1
ds_read_b64 v[192:193], v54 offset:12288
ds_read_b64 v[194:195], v54 offset:12800
ds_read_b64 v[196:197], v54 offset:13312
ds_read_b64 v[198:199], v54 offset:13824
ds_read_b64 v[200:201], v54 offset:14336
ds_read_b64 v[202:203], v54 offset:14848
ds_read_b64 v[204:205], v54 offset:15360
ds_read_b64 v[206:207], v54 offset:15872
ds_read_b128 v[160:163], v55 offset:4096
ds_read_b128 v[164:167], v55 offset:5120
ds_read_b128 v[168:171], v55 offset:6144
ds_read_b128 v[172:175], v55 offset:7168
ds_read_b128 v[176:179], v55 offset:8192
ds_read_b128 v[180:183], v55 offset:9216
ds_read_b128 v[184:187], v55 offset:10240
ds_read_b128 v[188:191], v55 offset:11264
s_waitcnt lgkmcnt(8)
v_max3_f32 v30, v192, v194, v196
v_max3_f32 v30, v30, v198, v200
v_max3_f32 v30, v30, v202, v204
v_max_f32 v30, v30, v206
v_sub_f32 v192, v192, v30
v_sub_f32 v194, v194, v30
v_sub_f32 v196, v196, v30
v_sub_f32 v198, v198, v30
v_sub_f32 v200, v200, v30
v_sub_f32 v202, v202, v30
v_sub_f32 v204, v204, v30
v_sub_f32 v206, v206, v30
v_exp_f32 v192, v192
v_exp_f32 v194, v194
v_exp_f32 v196, v196
v_exp_f32 v198, v198
v_exp_f32 v200, v200
v_exp_f32 v202, v202
v_exp_f32 v204, v204
v_exp_f32 v206, v206
s_waitcnt lgkmcnt(0)
v_mul_f32 v31, v192, v193
v_mul_f32 v26, v192, v160
v_mul_f32 v27, v192, v161
v_mul_f32 v28, v192, v162
v_mul_f32 v29, v192, v163
v_fmac_f32 v31, v194, v195
v_fmac_f32 v26, v194, v164
v_fmac_f32 v27, v194, v165
v_fmac_f32 v28, v194, v166
v_fmac_f32 v29, v194, v167
v_fmac_f32 v31, v196, v197
v_fmac_f32 v26, v196, v168
v_fmac_f32 v27, v196, v169
v_fmac_f32 v28, v196, v170
v_fmac_f32 v29, v196, v171
v_fmac_f32 v31, v198, v199
v_fmac_f32 v26, v198, v172
v_fmac_f32 v27, v198, v173
v_fmac_f32 v28, v198, v174
v_fmac_f32 v29, v198, v175
v_fmac_f32 v31, v200, v201
v_fmac_f32 v26, v200, v176
v_fmac_f32 v27, v200, v177
v_fmac_f32 v28, v200, v178
v_fmac_f32 v29, v200, v179
v_fmac_f32 v31, v202, v203
v_fmac_f32 v26, v202, v180
v_fmac_f32 v27, v202, v181
v_fmac_f32 v28, v202, v182
v_fmac_f32 v29, v202, v183
v_fmac_f32 v31, v204, v205
v_fmac_f32 v26, v204, v184
v_fmac_f32 v27, v204, v185
v_fmac_f32 v28, v204, v186
v_fmac_f32 v29, v204, v187
v_fmac_f32 v31, v206, v207
v_fmac_f32 v26, v206, v188
v_fmac_f32 v27, v206, v189
v_fmac_f32 v28, v206, v190
v_fmac_f32 v29, v206, v191
v_rcp_f32 v32, v31
v_log_f32 v31, v31
v_lshlrev_b32 v54, 10, v2
v_lshl_add_u32 v54, v3, 4, v54
s_lshl_b32 s67, s62, 14
s_lshl_b32 s68, s65, 6
s_add_u32 s67, s67, s68
s_add_u32 s67, s67, 524288
v_mul_f32 v26, v26, v32
v_mul_f32 v27, v27, v32
v_mul_f32 v28, v28, v32
v_mul_f32 v29, v29, v32
v_cvt_pk_bf16_f32 v26, v26, v27
v_cvt_pk_bf16_f32 v27, v28, v29
v_add_f32 v28, v30, v31
v_mov_b32 v29, s80
buffer_store_dwordx4 v[26:29], v54, s[12:15], s67 offen sc1
L_h1:
v_lshlrev_b32 v54, 6, v2
v_lshl_add_u32 v54, v3, 4, v54
s_lshl_b32 s67, s62, 4
s_add_u32 s67, s67, s65
s_lshl_b32 s67, s67, 10
s_add_u32 s67, s67, 524288
s_mov_b32 s70, 262144
L_poll22:
buffer_load_dwordx4 v[32:35], v54, s[12:15], s67 offen sc1
s_waitcnt vmcnt(0)
v_xor_b32 v38, s80, v35
v_cmp_ne_u32 vcc, 0, v38
s_cbranch_vccz L_done23
s_sub_u32 s70, s70, 1
s_cbranch_scc0 L_poll22
L_done23:
v_mov_b32 v38, v34
v_mov_b32 v37, v34
v_and_b32 v35, 0xffff0000, v33
v_lshlrev_b32 v34, 16, v33
v_and_b32 v33, 0xffff0000, v32
v_lshlrev_b32 v32, 16, v32
s_nop 1
v_max_f32_dpp v38, v38, v38 quad_perm:[1,0,3,2] row_mask:0xf bank_mask:0xf
s_nop 1
v_max_f32_dpp v38, v38, v38 quad_perm:[2,3,0,1] row_mask:0xf bank_mask:0xf
s_nop 1
v_max_f32_dpp v38, v38, v38 row_half_mirror row_mask:0xf bank_mask:0xf
v_sub_f32 v37, v37, v38
v_exp_f32 v37, v37
s_nop 0
v_mul_f32 v32, v32, v37
v_mul_f32 v33, v33, v37
v_mul_f32 v34, v34, v37
v_mul_f32 v35, v35, v37
v_add_f32_dpp v37, v37, v37 quad_perm:[1,0,3,2] row_mask:0xf bank_mask:0xf
v_add_f32_dpp v32, v32, v32 quad_perm:[1,0,3,2] row_mask:0xf bank_mask:0xf
v_add_f32_dpp v33, v33, v33 quad_perm:[1,0,3,2] row_mask:0xf bank_mask:0xf
v_add_f32_dpp v34, v34, v34 quad_perm:[1,0,3,2] row_mask:0xf bank_mask:0xf
v_add_f32_dpp v35, v35, v35 quad_perm:[1,0,3,2] row_mask:0xf bank_mask:0xf
v_add_f32_dpp v37, v37, v37 quad_perm:[2,3,0,1] row_mask:0xf bank_mask:0xf
v_add_f32_dpp v32, v32, v32 quad_perm:[2,3,0,1] row_mask:0xf bank_mask:0xf
v_add_f32_dpp v33, v33, v33 quad_perm:[2,3,0,1] row_mask:0xf bank_mask:0xf
v_add_f32_dpp v34, v34, v34 quad_perm:[2,3,0,1] row_mask:0xf bank_mask:0xf
v_add_f32_dpp v35, v35, v35 quad_perm:[2,3,0,1] row_mask:0xf bank_mask:0xf
v_add_f32_dpp v37, v37, v37 row_half_mirror row_mask:0xf bank_mask:0xf
v_add_f32_dpp v32, v32, v32 row_half_mirror row_mask:0xf bank_mask:0xf
v_add_f32_dpp v33, v33, v33 row_half_mirror row_mask:0xf bank_mask:0xf
v_add_f32_dpp v34, v34, v34 row_half_mirror row_mask:0xf bank_mask:0xf
v_add_f32_dpp v35, v35, v35 row_half_mirror row_mask:0xf bank_mask:0xf
v_rcp_f32 v37, v37
s_nop 0
v_mul_f32 v32, v32, v37
v_mul_f32 v33, v33, v37
v_mul_f32 v34, v34, v37
v_mul_f32 v35, v35, v37
v_cvt_pk_bf16_f32 v39, v32, v32
v_and_b32 v40, v6, v39
v_and_b32 v41, v7, v39
v_and_b32 v42, v8, v39
v_and_b32 v43, v9, v39
v_cvt_pk_bf16_f32 v39, v33, v33
v_and_b32 v44, v6, v39
v_and_b32 v45, v7, v39
v_and_b32 v46, v8, v39
v_and_b32 v47, v9, v39
v_mfma_f32_16x16x32_bf16 v[26:29], v[64:67], v[40:43], 0
v_cvt_pk_bf16_f32 v39, v34, v34
v_and_b32 v40, v6, v39
v_and_b32 v41, v7, v39
v_and_b32 v42, v8, v39
v_and_b32 v43, v9, v39
v_mfma_f32_16x16x32_bf16 v[26:29], v[68:71], v[44:47], v[26:29]
v_cvt_pk_bf16_f32 v39, v35, v35
v_and_b32 v44, v6, v39
v_and_b32 v45, v7, v39
v_and_b32 v46, v8, v39
v_and_b32 v47, v9, v39
v_mfma_f32_16x16x32_bf16 v[26:29], v[72:75], v[40:43], v[26:29]
s_nop 1
v_mfma_f32_16x16x32_bf16 v[26:29], v[76:79], v[44:47], v[26:29]
s_nop 1
s_lshl_b32 s67, s3, 18
s_lshl_b32 s68, s2, 5
s_add_u32 s67, s67, s68
s_add_u32 s67, s67, 1048576
s_nop 0
s_mov_b32 s68, 0x07060501
s_mov_b32 s69, 0x07060502
s_mov_b32 s79, 0x07060503
v_perm_b32 v26, v26, v29, s68
v_perm_b32 v27, v27, v29, s69
v_perm_b32 v28, v28, v29, s79
v_mov_b32 v29, s80
s_cmp_eq_u32 s3, 4
s_cselect_b32 exec_hi, 0, -1
buffer_store_dwordx4 v[26:29], v52, s[12:15], s67 offen sc1
s_mov_b32 exec_hi, -1
s_barrier
s_cmp_lt_u32 s2, 112
s_cbranch_scc1 L_end
L_mlp0:
s_cmp_lt_u32 s2, 112
s_cbranch_scc1 L_mlp24
s_cmp_gt_u32 s3, 5
s_cbranch_scc1 L_mlp24
s_mov_b32 s24, s48
s_and_b32 s25, s49, 0xffff
s_mov_b32 s26, 5308416
s_mov_b32 s27, 0x20000
s_mul_i32 s67, s3, 884736
s_lshl_b32 s68, s89, 6
s_add_u32 s67, s67, s68
v_mul_u32_u24 v49, 73728, v3
v_lshl_add_u32 v49, v2, 2, v49
buffer_load_dword v80, v49, s[24:27], s67 offen nt
s_add_u32 s67, s67, 9216
buffer_load_dword v81, v49, s[24:27], s67 offen nt
s_add_u32 s67, s67, 9216
buffer_load_dword v82, v49, s[24:27], s67 offen nt
s_add_u32 s67, s67, 9216
buffer_load_dword v83, v49, s[24:27], s67 offen nt
s_add_u32 s67, s67, 9216
buffer_load_dword v84, v49, s[24:27], s67 offen nt
s_add_u32 s67, s67, 9216
buffer_load_dword v85, v49, s[24:27], s67 offen nt
s_add_u32 s67, s67, 9216
buffer_load_dword v86, v49, s[24:27], s67 offen nt
s_add_u32 s67, s67, 9216
buffer_load_dword v87, v49, s[24:27], s67 offen nt
s_add_u32 s67, s67, 230400
buffer_load_dword v88, v49, s[24:27], s67 offen nt
s_add_u32 s67, s67, 9216
buffer_load_dword v89, v49, s[24:27], s67 offen nt
s_add_u32 s67, s67, 9216
buffer_load_dword v90, v49, s[24:27], s67 offen nt
s_add_u32 s67, s67, 9216
buffer_load_dword v91, v49, s[24:27], s67 offen nt
s_add_u32 s67, s67, 9216
buffer_load_dword v92, v49, s[24:27], s67 offen nt
s_add_u32 s67, s67, 9216
buffer_load_dword v93, v49, s[24:27], s67 offen nt
s_add_u32 s67, s67, 9216
buffer_load_dword v94, v49, s[24:27], s67 offen nt
s_add_u32 s67, s67, 9216
buffer_load_dword v95, v49, s[24:27], s67 offen nt
s_add_u32 s67, s67, 230400
buffer_load_dword v96, v49, s[24:27], s67 offen nt
s_add_u32 s67, s67, 9216
buffer_load_dword v97, v49, s[24:27], s67 offen nt
s_add_u32 s67, s67, 9216
buffer_load_dword v98, v49, s[24:27], s67 offen nt
s_add_u32 s67, s67, 9216
buffer_load_dword v99, v49, s[24:27], s67 offen nt
s_add_u32 s67, s67, 9216
buffer_load_dword v100, v49, s[24:27], s67 offen nt
s_add_u32 s67, s67, 9216
buffer_load_dword v101, v49, s[24:27], s67 offen nt
s_add_u32 s67, s67, 9216
buffer_load_dword v102, v49, s[24:27], s67 offen nt
s_add_u32 s67, s67, 9216
buffer_load_dword v103, v49, s[24:27], s67 offen nt
s_cmp_gt_u32 s3, 4
s_cbranch_scc1 L_mlp24
s_mov_b32 s28, s52
s_and_b32 s29, s53, 0xffff
s_mov_b32 s30, 5308416
s_mov_b32 s31, 0x20000
s_mul_i32 s67, s89, 36864
s_lshl_b32 s68, s3, 8
s_add_u32 s67, s67, s68
v_mul_u32_u24 v50, 9216, v3
v_lshl_add_u32 v50, v2, 4, v50
buffer_load_dwordx4 v[104:107], v50, s[28:31], s67 offen offset:0 nt
buffer_load_dwordx4 v[108:111], v50, s[28:31], s67 offen offset:1152 nt
buffer_load_dwordx4 v[112:115], v50, s[28:31], s67 offen offset:2304 nt
buffer_load_dwordx4 v[116:119], v50, s[28:31], s67 offen offset:3456 nt
s_add_u32 s67, s67, 4608
buffer_load_dwordx4 v[120:123], v50, s[28:31], s67 offen offset:0 nt
buffer_load_dwordx4 v[124:127], v50, s[28:31], s67 offen offset:1152 nt
buffer_load_dwordx4 v[128:131], v50, s[28:31], s67 offen offset:2304 nt
buffer_load_dwordx4 v[132:135], v50, s[28:31], s67 offen offset:3456 nt
s_mov_b32 s24, s50
s_and_b32 s25, s51, 0xffff
s_mov_b32 s26, 9216
s_mov_b32 s27, 0x20000
v_and_b32 v51, 7, v2
v_lshl_add_u32 v51, v3, 3, v51
v_lshlrev_b32 v51, 1, v51
s_lshl_b32 s67, s89, 6
buffer_load_ushort v136, v51, s[24:27], s67 offen
L_mlp24:
L_mlp:
s_mov_b32 s68, 0x05040100
s_mov_b32 s69, 0x07060302
s_waitcnt vmcnt(0)
v_perm_b32 v160, v81, v80, s68
v_perm_b32 v164, v81, v80, s69
v_perm_b32 v161, v83, v82, s68
v_perm_b32 v165, v83, v82, s69
v_perm_b32 v162, v85, v84, s68
v_perm_b32 v166, v85, v84, s69
v_perm_b32 v163, v87, v86, s68
v_perm_b32 v167, v87, v86, s69
v_perm_b32 v168, v89, v88, s68
v_perm_b32 v172, v89, v88, s69
v_perm_b32 v169, v91, v90, s68
v_perm_b32 v173, v91, v90, s69
v_perm_b32 v170, v93, v92, s68
v_perm_b32 v174, v93, v92, s69
v_perm_b32 v171, v95, v94, s68
v_perm_b32 v175, v95, v94, s69
v_perm_b32 v176, v97, v96, s68
v_perm_b32 v180, v97, v96, s69
v_perm_b32 v177, v99, v98, s68
v_perm_b32 v181, v99, v98, s69
v_perm_b32 v178, v101, v100, s68
v_perm_b32 v182, v101, v100, s69
v_perm_b32 v179, v103, v102, s68
v_perm_b32 v183, v103, v102, s69
v_lshrrev_b32 v48, 3, v2
v_mul_u32_u24 v48, 1152, v48
v_lshl_add_u32 v48, v3, 4, v48
s_mul_i32 s67, s3, 192
v_add_u32 v48, s67, v48
s_lshl_b32 s67, s3, 11
v_lshl_add_u32 v49, v1, 4, s67
v_and_b32 v50, 1, v2
v_lshlrev_b32 v50, 10, v50
v_lshl_add_u32 v50, v1, 4, v50
v_bfe_u32 v51, v2, 1, 2
v_lshl_add_u32 v50, v51, 2, v50
s_barrier
ds_read_b128 v[184:187], v48 offset:0
ds_read_b128 v[188:191], v48 offset:64
ds_read_b128 v[192:195], v48 offset:128
s_waitcnt lgkmcnt(2)
v_mfma_f32_16x16x32_bf16 v[32:35], v[160:163], v[184:187], 0
v_mfma_f32_16x16x32_bf16 v[36:39], v[164:167], v[184:187], 0
s_waitcnt lgkmcnt(1)
v_mfma_f32_16x16x32_bf16 v[32:35], v[168:171], v[188:191], v[32:35]
v_mfma_f32_16x16x32_bf16 v[36:39], v[172:175], v[188:191], v[36:39]
s_waitcnt lgkmcnt(0)
v_mfma_f32_16x16x32_bf16 v[32:35], v[176:179], v[192:195], v[32:35]
v_mfma_f32_16x16x32_bf16 v[36:39], v[180:183], v[192:195], v[36:39]
s_nop 6
ds_write_b128 v49, v[32:35] offset:16384
ds_write_b128 v49, v[36:39] offset:17408
s_waitcnt lgkmcnt(0)
s_barrier
s_cmp_eq_u32 s3, 5
s_cbranch_scc1 L_end
ds_read_b32 v32, v50 offset:16384
ds_read_b32 v33, v50 offset:18432
ds_read_b32 v34, v50 offset:20480
ds_read_b32 v35, v50 offset:22528
ds_read_b32 v36, v50 offset:24576
ds_read_b32 v37, v50 offset:26624
v_lshlrev_b32 v136, 16, v136
s_waitcnt lgkmcnt(0)
v_add_f32 v32, v32, v33
v_add_f32 v34, v34, v35
v_add_f32 v36, v36, v37
v_add_f32 v32, v32, v34
v_add_f32 v32, v32, v36
v_cvt_pk_bf16_f32 v32, v32, v32
v_and_b32 v32, 0xffff0000, v32
v_add_f32 v32, v32, v136
v_cvt_pk_bf16_f32 v32, v32, v32
v_and_b32 v32, 0xffff0000, v32
v_mul_f32 v33, v32, v32
v_mov_b32 v34, 0xc0135761
v_fmac_f32 v34, 0xbdd2d3e8, v33
v_mul_f32 v33, v34, v32
v_exp_f32 v33, v33
s_nop 0
v_add_f32 v33, 1.0, v33
v_rcp_f32 v33, v33
s_nop 0
v_mul_f32 v32, v32, v33
v_cvt_pk_bf16_f32 v32, v32, v32
s_nop 1
v_mov_b32_dpp v39, v32 row_newbcast:0 row_mask:0xf bank_mask:0x3
v_mov_b32_dpp v39, v32 row_newbcast:8 row_mask:0xf bank_mask:0xc
v_and_b32 v40, v6, v39
v_and_b32 v41, v7, v39
v_and_b32 v42, v8, v39
v_and_b32 v43, v9, v39
v_mov_b32_dpp v39, v32 row_newbcast:1 row_mask:0xf bank_mask:0x3
v_mov_b32_dpp v39, v32 row_newbcast:9 row_mask:0xf bank_mask:0xc
v_and_b32 v44, v6, v39
v_and_b32 v45, v7, v39
v_and_b32 v46, v8, v39
v_and_b32 v47, v9, v39
v_mfma_f32_16x16x32_bf16 v[26:29], v[104:107], v[40:43], 0
v_mov_b32_dpp v39, v32 row_newbcast:2 row_mask:0xf bank_mask:0x3
v_mov_b32_dpp v39, v32 row_newbcast:10 row_mask:0xf bank_mask:0xc
v_and_b32 v40, v6, v39
v_and_b32 v41, v7, v39
v_and_b32 v42, v8, v39
v_and_b32 v43, v9, v39
v_mfma_f32_16x16x32_bf16 v[26:29], v[108:111], v[44:47], v[26:29]
v_mov_b32_dpp v39, v32 row_newbcast:3 row_mask:0xf bank_mask:0x3
v_mov_b32_dpp v39, v32 row_newbcast:11 row_mask:0xf bank_mask:0xc
v_and_b32 v44, v6, v39
v_and_b32 v45, v7, v39
v_and_b32 v46, v8, v39
v_and_b32 v47, v9, v39
v_mfma_f32_16x16x32_bf16 v[26:29], v[112:115], v[40:43], v[26:29]
v_mov_b32_dpp v39, v32 row_newbcast:4 row_mask:0xf bank_mask:0x3
v_mov_b32_dpp v39, v32 row_newbcast:12 row_mask:0xf bank_mask:0xc
v_and_b32 v40, v6, v39
v_and_b32 v41, v7, v39
v_and_b32 v42, v8, v39
v_and_b32 v43, v9, v39
v_mfma_f32_16x16x32_bf16 v[26:29], v[116:119], v[44:47], v[26:29]
v_mov_b32_dpp v39, v32 row_newbcast:5 row_mask:0xf bank_mask:0x3
v_mov_b32_dpp v39, v32 row_newbcast:13 row_mask:0xf bank_mask:0xc
v_and_b32 v44, v6, v39
v_and_b32 v45, v7, v39
v_and_b32 v46, v8, v39
v_and_b32 v47, v9, v39
v_mfma_f32_16x16x32_bf16 v[26:29], v[120:123], v[40:43], v[26:29]
v_mov_b32_dpp v39, v32 row_newbcast:6 row_mask:0xf bank_mask:0x3
v_mov_b32_dpp v39, v32 row_newbcast:14 row_mask:0xf bank_mask:0xc
v_and_b32 v40, v6, v39
v_and_b32 v41, v7, v39
v_and_b32 v42, v8, v39
v_and_b32 v43, v9, v39
v_mfma_f32_16x16x32_bf16 v[26:29], v[124:127], v[44:47], v[26:29]
v_mov_b32_dpp v39, v32 row_newbcast:7 row_mask:0xf bank_mask:0x3
v_mov_b32_dpp v39, v32 row_newbcast:15 row_mask:0xf bank_mask:0xc
v_and_b32 v44, v6, v39
v_and_b32 v45, v7, v39
v_and_b32 v46, v8, v39
v_and_b32 v47, v9, v39
v_mfma_f32_16x16x32_bf16 v[26:29], v[128:131], v[40:43], v[26:29]
s_nop 1
v_mfma_f32_16x16x32_bf16 v[26:29], v[132:135], v[44:47], v[26:29]
s_nop 1
s_lshl_b32 s67, s3, 18
s_lshl_b32 s68, s97, 5
s_add_u32 s67, s67, s68
s_add_u32 s67, s67, 6291456
s_nop 0
s_mov_b32 s68, 0x07060501
s_mov_b32 s69, 0x07060502
s_mov_b32 s79, 0x07060503
v_perm_b32 v26, v26, v29, s68
v_perm_b32 v27, v27, v29, s69
v_perm_b32 v28, v28, v29, s79
v_mov_b32 v29, s80
s_cmp_eq_u32 s3, 4
s_cselect_b32 exec_hi, 0, -1
buffer_store_dwordx4 v[26:29], v52, s[12:15], s67 offen sc1
s_mov_b32 exec_hi, -1
s_endpgm
L_w5:
s_cmp_lt_u32 s2, 112
s_cbranch_scc1 L_w7
s_barrier
s_branch L_mlp0
L_w7:
s_cmp_ge_u32 s2, 72
s_cbranch_scc1 L_end
s_lshl_b32 s96, s2, 1
s_bfe_u32 s67, s3, 0x10001
s_add_u32 s96, s96, s67
s_lshl_b32 s67, s96, 1
v_add_u32 v53, s67, v53
v_lshrrev_b32 v54, 4, v53
v_lshlrev_b32 v54, 5, v54
v_and_b32 v55, 7, v53
v_add_u32 v54, v54, v55
v_bfe_u32 v56, v53, 3, 1
v_mul_u32_u24 v56, 576, v56
v_add_u32 v56, v56, v54
v_lshlrev_b32 v54, 1, v54
v_lshlrev_b32 v57, 1, v56
s_mov_b32 s20, s36
s_and_b32 s21, s37, 0xffff
s_mov_b32 s22, 2304
s_mov_b32 s23, 0x20000
s_mov_b32 s28, s54
s_and_b32 s29, s55, 0xffff
s_mov_b32 s30, 1152
s_mov_b32 s31, 0x20000
buffer_load_ushort v240, v57, s[20:23], 0 offen offset:0
buffer_load_ushort v244, v54, s[28:31], 0 offen offset:0
buffer_load_ushort v241, v57, s[20:23], 0 offen offset:16
buffer_load_ushort v245, v54, s[28:31], 0 offen offset:16
buffer_load_ushort v242, v57, s[20:23], 0 offen offset:32
buffer_load_ushort v246, v54, s[28:31], 0 offen offset:32
buffer_load_ushort v243, v57, s[20:23], 0 offen offset:48
buffer_load_ushort v247, v54, s[28:31], 0 offen offset:48
s_mov_b32 s68, 0x0c0c0400
s_mov_b32 s69, 0x0401000c
v_lshlrev_b32 v61, 4, v1
s_lshl_b32 s78, s96, 13
s_add_u32 s81, s78, 1048576
s_add_u32 s82, s81, 1024
s_add_u32 s83, s81, 2048
s_add_u32 s84, s81, 3072
s_add_u32 s85, s81, 4096
s_add_u32 s86, s81, 5120
s_add_u32 s87, s81, 6144
s_add_u32 s88, s81, 7168
s_barrier
s_mov_b32 s70, 262144
L_poll26:
buffer_load_dwordx4 v[200:203], v61, s[12:15], s81 offen sc1
buffer_load_dwordx4 v[204:207], v61, s[12:15], s82 offen sc1
buffer_load_dwordx4 v[208:211], v61, s[12:15], s83 offen sc1
buffer_load_dwordx4 v[212:215], v61, s[12:15], s84 offen sc1
buffer_load_dwordx4 v[216:219], v61, s[12:15], s85 offen sc1
buffer_load_dwordx4 v[220:223], v61, s[12:15], s86 offen sc1
buffer_load_dwordx4 v[224:227], v61, s[12:15], s87 offen sc1
buffer_load_dwordx4 v[228:231], v61, s[12:15], s88 offen sc1
s_waitcnt vmcnt(0)
v_xor_b32 v38, s80, v203
v_xor_b32 v39, s80, v207
v_or_b32 v38, v38, v39
v_xor_b32 v39, s80, v211
v_or_b32 v38, v38, v39
v_xor_b32 v39, s80, v215
v_or_b32 v38, v38, v39
v_xor_b32 v39, s80, v219
v_or_b32 v38, v38, v39
v_xor_b32 v39, s80, v223
v_or_b32 v38, v38, v39
v_xor_b32 v39, s80, v227
v_or_b32 v38, v38, v39
v_xor_b32 v39, s80, v231
v_or_b32 v38, v38, v39
v_cmp_ne_u32 vcc, 0, v38
s_cbranch_vccz L_done27
s_sub_u32 s70, s70, 1
s_cbranch_scc0 L_poll26
L_done27:
v_perm_b32 v203, v201, v200, s68
v_perm_b32 v203, v202, v203, s69
v_perm_b32 v207, v205, v204, s68
v_perm_b32 v207, v206, v207, s69
v_perm_b32 v211, v209, v208, s68
v_perm_b32 v211, v210, v211, s69
v_perm_b32 v215, v213, v212, s68
v_perm_b32 v215, v214, v215, s69
v_perm_b32 v219, v217, v216, s68
v_perm_b32 v219, v218, v219, s69
v_perm_b32 v223, v221, v220, s68
v_perm_b32 v223, v222, v223, s69
v_perm_b32 v227, v225, v224, s68
v_perm_b32 v227, v226, v227, s69
v_perm_b32 v231, v229, v228, s68
v_perm_b32 v231, v230, v231, s69
v_add_f32 v200, v200, v216
v_add_f32 v201, v201, v217
v_add_f32 v202, v202, v218
v_add_f32 v203, v203, v219
v_add_f32 v204, v204, v220
v_add_f32 v205, v205, v221
v_add_f32 v206, v206, v222
v_add_f32 v207, v207, v223
v_add_f32 v208, v208, v224
v_add_f32 v209, v209, v225
v_add_f32 v210, v210, v226
v_add_f32 v211, v211, v227
v_add_f32 v212, v212, v228
v_add_f32 v213, v213, v229
v_add_f32 v214, v214, v230
v_add_f32 v215, v215, v231
v_add_f32 v200, v200, v208
v_add_f32 v201, v201, v209
v_add_f32 v202, v202, v210
v_add_f32 v203, v203, v211
v_add_f32 v204, v204, v212
v_add_f32 v205, v205, v213
v_add_f32 v206, v206, v214
v_add_f32 v207, v207, v215
v_add_f32 v200, v200, v204
v_add_f32 v201, v201, v205
v_add_f32 v202, v202, v206
v_add_f32 v203, v203, v207
v_add_f32_dpp v200, v200, v200 quad_perm:[2,3,0,1] row_mask:0xf bank_mask:0xf
v_add_f32_dpp v201, v201, v201 quad_perm:[2,3,0,1] row_mask:0xf bank_mask:0xf
v_add_f32_dpp v202, v202, v202 quad_perm:[2,3,0,1] row_mask:0xf bank_mask:0xf
v_add_f32_dpp v203, v203, v203 quad_perm:[2,3,0,1] row_mask:0xf bank_mask:0xf
v_add_f32_dpp v200, v200, v200 row_ror:4 row_mask:0xf bank_mask:0xf
v_add_f32_dpp v201, v201, v201 row_ror:4 row_mask:0xf bank_mask:0xf
v_add_f32_dpp v202, v202, v202 row_ror:4 row_mask:0xf bank_mask:0xf
v_add_f32_dpp v203, v203, v203 row_ror:4 row_mask:0xf bank_mask:0xf
v_add_f32_dpp v200, v200, v200 row_ror:8 row_mask:0xf bank_mask:0xf
v_add_f32_dpp v201, v201, v201 row_ror:8 row_mask:0xf bank_mask:0xf
v_add_f32_dpp v202, v202, v202 row_ror:8 row_mask:0xf bank_mask:0xf
v_add_f32_dpp v203, v203, v203 row_ror:8 row_mask:0xf bank_mask:0xf
v_mov_b32 v44, v200
v_mov_b32 v45, v201
v_mov_b32 v46, v202
v_mov_b32 v47, v203
s_nop 1
v_permlane16_swap_b32 v200, v44
v_permlane16_swap_b32 v201, v45
v_permlane16_swap_b32 v202, v46
v_permlane16_swap_b32 v203, v47
v_add_f32 v200, v200, v44
v_add_f32 v201, v201, v45
v_add_f32 v202, v202, v46
v_add_f32 v203, v203, v47
v_mov_b32 v44, v200
v_mov_b32 v45, v201
v_mov_b32 v46, v202
v_mov_b32 v47, v203
s_nop 1
v_permlane32_swap_b32 v200, v44
v_permlane32_swap_b32 v201, v45
v_permlane32_swap_b32 v202, v46
v_permlane32_swap_b32 v203, v47
v_add_f32 v200, v200, v44
v_add_f32 v201, v201, v45
v_add_f32 v202, v202, v46
v_add_f32 v203, v203, v47
v_cvt_pk_bf16_f32 v200, v200, v201
v_cvt_pk_bf16_f32 v202, v202, v203
v_lshlrev_b32 v240, 16, v240
v_lshlrev_b32 v241, 16, v241
v_lshlrev_b32 v242, 16, v242
v_lshlrev_b32 v243, 16, v243
v_and_b32 v205, 0xffff0000, v200
v_lshlrev_b32 v204, 16, v200
v_and_b32 v207, 0xffff0000, v202
v_lshlrev_b32 v206, 16, v202
v_add_f32 v240, v240, v204
v_add_f32 v241, v241, v205
v_add_f32 v242, v242, v206
v_add_f32 v243, v243, v207
v_cvt_pk_bf16_f32 v248, v240, v241
v_cvt_pk_bf16_f32 v249, v242, v243
v_mov_b32 v250, s80
v_mov_b32 v251, s80
s_lshl_b32 s67, s96, 5
s_add_u32 s67, s67, 294912
s_mov_b64 exec, 3
buffer_store_dwordx4 v[248:251], v61, s[12:15], s67 offen sc1
s_mov_b64 exec, -1
L_w5b:
s_add_u32 s81, s78, 6291456
s_add_u32 s82, s81, 1024
s_add_u32 s83, s81, 2048
s_add_u32 s84, s81, 3072
s_add_u32 s85, s81, 4096
v_mov_b32 v216, 0
v_mov_b32 v217, 0
v_mov_b32 v218, 0
v_mov_b32 v219, s80
s_mov_b32 s68, 0x0c0c0400
s_mov_b32 s69, 0x0401000c
s_mov_b32 s70, 262144
L_poll28:
buffer_load_dwordx4 v[200:203], v61, s[12:15], s81 offen sc1
buffer_load_dwordx4 v[204:207], v61, s[12:15], s82 offen sc1
buffer_load_dwordx4 v[208:211], v61, s[12:15], s83 offen sc1
buffer_load_dwordx4 v[212:215], v61, s[12:15], s84 offen sc1
s_mov_b32 exec_hi, 0
buffer_load_dwordx4 v[216:219], v61, s[12:15], s85 offen sc1
s_mov_b32 exec_hi, -1
s_waitcnt vmcnt(0)
v_xor_b32 v38, s80, v203
v_xor_b32 v39, s80, v207
v_or_b32 v38, v38, v39
v_xor_b32 v39, s80, v211
v_or_b32 v38, v38, v39
v_xor_b32 v39, s80, v215
v_or_b32 v38, v38, v39
v_xor_b32 v39, s80, v219
v_or_b32 v38, v38, v39
v_cmp_ne_u32 vcc, 0, v38
s_cbranch_vccz L_done29
s_sub_u32 s70, s70, 1
s_cbranch_scc0 L_poll28
L_done29:
v_perm_b32 v203, v201, v200, s68
v_perm_b32 v203, v202, v203, s69
v_perm_b32 v207, v205, v204, s68
v_perm_b32 v207, v206, v207, s69
v_perm_b32 v211, v209, v208, s68
v_perm_b32 v211, v210, v211, s69
v_perm_b32 v215, v213, v212, s68
v_perm_b32 v215, v214, v215, s69
v_perm_b32 v219, v217, v216, s68
v_perm_b32 v219, v218, v219, s69
v_add_f32 v200, v200, v216
v_add_f32 v201, v201, v217
v_add_f32 v202, v202, v218
v_add_f32 v203, v203, v219
v_add_f32 v200, v200, v208
v_add_f32 v201, v201, v209
v_add_f32 v202, v202, v210
v_add_f32 v203, v203, v211
v_add_f32 v204, v204, v212
v_add_f32 v205, v205, v213
v_add_f32 v206, v206, v214
v_add_f32 v207, v207, v215
v_add_f32 v200, v200, v204
v_add_f32 v201, v201, v205
v_add_f32 v202, v202, v206
v_add_f32 v203, v203, v207
v_add_f32_dpp v200, v200, v200 quad_perm:[2,3,0,1] row_mask:0xf bank_mask:0xf
v_add_f32_dpp v201, v201, v201 quad_perm:[2,3,0,1] row_mask:0xf bank_mask:0xf
v_add_f32_dpp v202, v202, v202 quad_perm:[2,3,0,1] row_mask:0xf bank_mask:0xf
v_add_f32_dpp v203, v203, v203 quad_perm:[2,3,0,1] row_mask:0xf bank_mask:0xf
v_add_f32_dpp v200, v200, v200 row_ror:4 row_mask:0xf bank_mask:0xf
v_add_f32_dpp v201, v201, v201 row_ror:4 row_mask:0xf bank_mask:0xf
v_add_f32_dpp v202, v202, v202 row_ror:4 row_mask:0xf bank_mask:0xf
v_add_f32_dpp v203, v203, v203 row_ror:4 row_mask:0xf bank_mask:0xf
v_add_f32_dpp v200, v200, v200 row_ror:8 row_mask:0xf bank_mask:0xf
v_add_f32_dpp v201, v201, v201 row_ror:8 row_mask:0xf bank_mask:0xf
v_add_f32_dpp v202, v202, v202 row_ror:8 row_mask:0xf bank_mask:0xf
v_add_f32_dpp v203, v203, v203 row_ror:8 row_mask:0xf bank_mask:0xf
v_mov_b32 v44, v200
v_mov_b32 v45, v201
v_mov_b32 v46, v202
v_mov_b32 v47, v203
s_nop 1
v_permlane16_swap_b32 v200, v44
v_permlane16_swap_b32 v201, v45
v_permlane16_swap_b32 v202, v46
v_permlane16_swap_b32 v203, v47
v_add_f32 v200, v200, v44
v_add_f32 v201, v201, v45
v_add_f32 v202, v202, v46
v_add_f32 v203, v203, v47
v_mov_b32 v44, v200
v_mov_b32 v45, v201
v_mov_b32 v46, v202
v_mov_b32 v47, v203
s_nop 1
v_permlane32_swap_b32 v200, v44
v_permlane32_swap_b32 v201, v45
v_permlane32_swap_b32 v202, v46
v_permlane32_swap_b32 v203, v47
v_add_f32 v200, v200, v44
v_add_f32 v201, v201, v45
v_add_f32 v202, v202, v46
v_add_f32 v203, v203, v47
v_cvt_pk_bf16_f32 v200, v200, v201
v_cvt_pk_bf16_f32 v202, v202, v203
v_lshlrev_b32 v244, 16, v244
v_lshlrev_b32 v245, 16, v245
v_lshlrev_b32 v246, 16, v246
v_lshlrev_b32 v247, 16, v247
v_and_b32 v205, 0xffff0000, v200
v_lshlrev_b32 v204, 16, v200
v_and_b32 v207, 0xffff0000, v202
v_lshlrev_b32 v206, 16, v202
v_add_f32 v244, v244, v204
v_add_f32 v245, v245, v205
v_add_f32 v246, v246, v206
v_add_f32 v247, v247, v207
v_cvt_pk_bf16_f32 v200, v244, v245
v_cvt_pk_bf16_f32 v202, v246, v247
v_and_b32 v241, 0xffff0000, v248
v_lshlrev_b32 v240, 16, v248
v_and_b32 v243, 0xffff0000, v249
v_lshlrev_b32 v242, 16, v249
v_and_b32 v205, 0xffff0000, v200
v_lshlrev_b32 v204, 16, v200
v_and_b32 v207, 0xffff0000, v202
v_lshlrev_b32 v206, 16, v202
v_add_f32 v240, v240, v204
v_add_f32 v241, v241, v205
v_add_f32 v242, v242, v206
v_add_f32 v243, v243, v207
v_cvt_pk_bf16_f32 v200, v240, v241
v_cvt_pk_bf16_f32 v202, v242, v243
s_mov_b32 s20, s56
s_and_b32 s21, s57, 0xffff
s_mov_b32 s22, 2304
s_mov_b32 s23, 0x20000
s_mov_b64 exec, 3
buffer_store_short v200, v57, s[20:23], 0 offen
buffer_store_short_d16_hi v200, v57, s[20:23], 0 offen offset:16
buffer_store_short v202, v57, s[20:23], 0 offen offset:32
buffer_store_short_d16_hi v202, v57, s[20:23], 0 offen offset:48
s_mov_b64 exec, -1
s_cmp_lg_u32 s96, 0
s_cbranch_scc1 L_end
v_mov_b32 v48, s80
s_mov_b32 s67, 262144
s_mov_b64 exec, 1
buffer_store_dword v48, v61, s[12:15], s67 offen
s_mov_b64 exec, -1
s_endpgm
L_w6:
s_cmp_lt_u32 s2, 112
s_cbranch_scc1 L_end
v_bfe_u32 v50, v2, 3, 1
v_mul_u32_u24 v50, 1152, v50
v_lshl_add_u32 v50, v3, 6, v50
v_and_b32 v49, 7, v2
v_lshl_add_u32 v50, v49, 1, v50
s_mov_b32 s81, 294912
s_mov_b32 s82, 295936
s_mov_b32 s83, 296960
s_mov_b32 s84, 297984
s_mov_b32 s85, 299008
v_mov_b32 v216, 0
v_mov_b32 v217, 0
v_mov_b32 v218, 0
v_mov_b32 v219, s80
s_barrier
s_mov_b32 s70, 262144
L_poll30:
buffer_load_dwordx4 v[200:203], v61, s[12:15], s81 offen sc1
buffer_load_dwordx4 v[204:207], v61, s[12:15], s82 offen sc1
buffer_load_dwordx4 v[208:211], v61, s[12:15], s83 offen sc1
buffer_load_dwordx4 v[212:215], v61, s[12:15], s84 offen sc1
s_mov_b32 exec_hi, 0
buffer_load_dwordx4 v[216:219], v61, s[12:15], s85 offen sc1
s_mov_b32 exec_hi, -1
s_waitcnt vmcnt(0)
v_xor_b32 v38, s80, v203
v_xor_b32 v39, s80, v207
v_or_b32 v38, v38, v39
v_xor_b32 v39, s80, v211
v_or_b32 v38, v38, v39
v_xor_b32 v39, s80, v215
v_or_b32 v38, v38, v39
v_xor_b32 v39, s80, v219
v_or_b32 v38, v38, v39
v_cmp_ne_u32 vcc, 0, v38
s_cbranch_vccz L_done31
s_sub_u32 s70, s70, 1
s_cbranch_scc0 L_poll30
L_done31:
v_and_b32 v203, 0xffff0000, v201
v_lshlrev_b32 v202, 16, v201
v_and_b32 v201, 0xffff0000, v200
v_lshlrev_b32 v200, 16, v200
v_and_b32 v207, 0xffff0000, v205
v_lshlrev_b32 v206, 16, v205
v_and_b32 v205, 0xffff0000, v204
v_lshlrev_b32 v204, 16, v204
v_and_b32 v211, 0xffff0000, v209
v_lshlrev_b32 v210, 16, v209
v_and_b32 v209, 0xffff0000, v208
v_lshlrev_b32 v208, 16, v208
v_and_b32 v215, 0xffff0000, v213
v_lshlrev_b32 v214, 16, v213
v_and_b32 v213, 0xffff0000, v212
v_lshlrev_b32 v212, 16, v212
v_and_b32 v219, 0xffff0000, v217
v_lshlrev_b32 v218, 16, v217
v_and_b32 v217, 0xffff0000, v216
v_lshlrev_b32 v216, 16, v216
v_add_f32 v40, v200, v201
v_add_f32 v40, v40, v202
v_add_f32 v40, v40, v203
v_add_f32 v40, v40, v204
v_add_f32 v40, v40, v205
v_add_f32 v40, v40, v206
v_add_f32 v40, v40, v207
v_add_f32 v40, v40, v208
v_add_f32 v40, v40, v209
v_add_f32 v40, v40, v210
v_add_f32 v40, v40, v211
v_add_f32 v40, v40, v212
v_add_f32 v40, v40, v213
v_add_f32 v40, v40, v214
v_add_f32 v40, v40, v215
v_add_f32 v40, v40, v216
v_add_f32 v40, v40, v217
v_add_f32 v40, v40, v218
v_add_f32 v40, v40, v219
s_nop 1
v_add_f32_dpp v40, v40, v40 quad_perm:[1,0,3,2] row_mask:0xf bank_mask:0xf
s_nop 1
v_add_f32_dpp v40, v40, v40 quad_perm:[2,3,0,1] row_mask:0xf bank_mask:0xf
s_nop 1
v_add_f32_dpp v40, v40, v40 row_half_mirror row_mask:0xf bank_mask:0xf
v_mov_b32 v41, v40
s_nop 1
v_permlane16_swap_b32 v40, v41
v_add_f32 v40, v40, v41
v_mov_b32 v41, v40
s_nop 1
v_permlane32_swap_b32 v40, v41
v_add_f32 v40, v40, v41
v_mul_f32 v40, 0x3ae38e39, v40
v_sub_f32 v200, v200, v40
v_sub_f32 v201, v201, v40
v_sub_f32 v202, v202, v40
v_sub_f32 v203, v203, v40
v_sub_f32 v204, v204, v40
v_sub_f32 v205, v205, v40
v_sub_f32 v206, v206, v40
v_sub_f32 v207, v207, v40
v_sub_f32 v208, v208, v40
v_sub_f32 v209, v209, v40
v_sub_f32 v210, v210, v40
v_sub_f32 v211, v211, v40
v_sub_f32 v212, v212, v40
v_sub_f32 v213, v213, v40
v_sub_f32 v214, v214, v40
v_sub_f32 v215, v215, v40
s_mov_b32 exec_hi, 0
v_sub_f32 v216, v216, v40
v_sub_f32 v217, v217, v40
v_sub_f32 v218, v218, v40
v_sub_f32 v219, v219, v40
s_mov_b32 exec_hi, -1
v_mul_f32 v40, v200, v200
v_fmac_f32 v40, v201, v201
v_fmac_f32 v40, v202, v202
v_fmac_f32 v40, v203, v203
v_fmac_f32 v40, v204, v204
v_fmac_f32 v40, v205, v205
v_fmac_f32 v40, v206, v206
v_fmac_f32 v40, v207, v207
v_fmac_f32 v40, v208, v208
v_fmac_f32 v40, v209, v209
v_fmac_f32 v40, v210, v210
v_fmac_f32 v40, v211, v211
v_fmac_f32 v40, v212, v212
v_fmac_f32 v40, v213, v213
v_fmac_f32 v40, v214, v214
v_fmac_f32 v40, v215, v215
v_fmac_f32 v40, v216, v216
v_fmac_f32 v40, v217, v217
v_fmac_f32 v40, v218, v218
v_fmac_f32 v40, v219, v219
s_nop 1
v_add_f32_dpp v40, v40, v40 quad_perm:[1,0,3,2] row_mask:0xf bank_mask:0xf
s_nop 1
v_add_f32_dpp v40, v40, v40 quad_perm:[2,3,0,1] row_mask:0xf bank_mask:0xf
s_nop 1
v_add_f32_dpp v40, v40, v40 row_half_mirror row_mask:0xf bank_mask:0xf
v_mov_b32 v41, v40
s_nop 1
v_permlane16_swap_b32 v40, v41
v_add_f32 v40, v40, v41
v_mov_b32 v41, v40
s_nop 1
v_permlane32_swap_b32 v40, v41
v_add_f32 v40, v40, v41
v_mov_b32 v41, 0x3727c5ac
v_fmac_f32 v41, 0x3ae38e39, v40
v_rsq_f32 v40, v41
s_nop 0
v_mul_f32 v200, v200, v40
v_mul_f32 v201, v201, v40
v_mul_f32 v202, v202, v40
v_mul_f32 v203, v203, v40
v_mul_f32 v204, v204, v40
v_mul_f32 v205, v205, v40
v_mul_f32 v206, v206, v40
v_mul_f32 v207, v207, v40
v_mul_f32 v208, v208, v40
v_mul_f32 v209, v209, v40
v_mul_f32 v210, v210, v40
v_mul_f32 v211, v211, v40
v_mul_f32 v212, v212, v40
v_mul_f32 v213, v213, v40
v_mul_f32 v214, v214, v40
v_mul_f32 v215, v215, v40
v_mul_f32 v216, v216, v40
v_mul_f32 v217, v217, v40
v_mul_f32 v218, v218, v40
v_mul_f32 v219, v219, v40
v_cvt_pk_bf16_f32 v200, v200, v201
v_cvt_pk_bf16_f32 v201, v202, v203
v_cvt_pk_bf16_f32 v202, v204, v205
v_cvt_pk_bf16_f32 v203, v206, v207
v_cvt_pk_bf16_f32 v204, v208, v209
v_cvt_pk_bf16_f32 v205, v210, v211
v_cvt_pk_bf16_f32 v206, v212, v213
v_cvt_pk_bf16_f32 v207, v214, v215
v_cvt_pk_bf16_f32 v208, v216, v217
v_cvt_pk_bf16_f32 v209, v218, v219
ds_write_b16 v50, v200 offset:0
ds_write_b16_d16_hi v50, v200 offset:16
ds_write_b16 v50, v201 offset:32
ds_write_b16_d16_hi v50, v201 offset:48
ds_write_b16 v50, v202 offset:256
ds_write_b16_d16_hi v50, v202 offset:272
ds_write_b16 v50, v203 offset:288
ds_write_b16_d16_hi v50, v203 offset:304
ds_write_b16 v50, v204 offset:512
ds_write_b16_d16_hi v50, v204 offset:528
ds_write_b16 v50, v205 offset:544
ds_write_b16_d16_hi v50, v205 offset:560
ds_write_b16 v50, v206 offset:768
ds_write_b16_d16_hi v50, v206 offset:784
ds_write_b16 v50, v207 offset:800
ds_write_b16_d16_hi v50, v207 offset:816
s_mov_b32 exec_hi, 0
ds_write_b16 v50, v208 offset:1024
ds_write_b16_d16_hi v50, v208 offset:1040
ds_write_b16 v50, v209 offset:1056
ds_write_b16_d16_hi v50, v209 offset:1072
s_mov_b32 exec_hi, -1
s_waitcnt lgkmcnt(0)
s_barrier
L_end:
L_exit:
s_endpgm
.section .rodata,"a"
.p2align 6
.amdhsa_kernel sequential_preLN__gqa_block_cached__dense_activation_gelu__decode_kernel
.amdhsa_next_free_vgpr 256
.amdhsa_next_free_sgpr 102
.amdhsa_accum_offset 256
.amdhsa_group_segment_fixed_size 0
.amdhsa_kernarg_size 104
.amdhsa_user_sgpr_count 2
.amdhsa_user_sgpr_kernarg_segment_ptr 1
.amdhsa_system_sgpr_workgroup_id_x 1
.end_amdhsa_kernel
```
